```python
import torch

def _softmax(x, axis=-1):
    return torch.softmax(x, dim=axis)

def _gelu(x):
    return torch.nn.functional.gelu(x, approximate='tanh')

def _silu(x):
    return torch.nn.functional.silu(x)

def _sigmoid(x):
    return torch.sigmoid(x)

def _layernorm(x, axis=-1, eps=1e-05):
    m = x.mean(dim=axis, keepdim=True)
    v = x.var(dim=axis, keepdim=True, unbiased=False)
    return (x - m) / torch.sqrt(v + eps)

def _scatter_add(tgt, idx, src, axis=0):
    return tgt.clone().index_add_(axis, idx, src)

def _segment_sum(src, seg, n):
    out = torch.zeros((n,) + src.shape[1:], dtype=src.dtype)
    return out.index_add_(0, seg, src)

def _pad(x, pw):
    flat = tuple((v for pair in reversed(pw) for v in pair))
    return torch.nn.functional.pad(x, flat)
kernel_name = 'adaLN_cond__sliding_block_cached__dense_activation_squared_relu__decode'

def setup_inputs():

    _w = lambda a: (lambda t: t.to(torch.bfloat16) if t.is_floating_point() else t)(torch.as_tensor(a))

    def _A_setup():
        B, Sq, D = (4, 1, 512)
        Hq, Hkv, Sk, Dh = (32, 8, 8192, 128)
        assert Hq % Hkv == 0, (Hq, Hkv)
        return {'x': _w((lambda *s: torch.randn(*s, dtype=torch.bfloat16) * 0.05)(B, Sq, D)), 'k_cache': _w((lambda *s: torch.randn(*s, dtype=torch.bfloat16) * 3.2)(B, Hkv, Sk, Dh)), 'v_cache': _w((lambda *s: torch.randn(*s, dtype=torch.bfloat16) * 0.4)(B, Hkv, Sk, Dh)), 'wq': _w((lambda *s: torch.randn(*s, dtype=torch.bfloat16) * 3.2)(D, Hq * Dh) * D ** (-0.5)), 'wo': _w((lambda *s: torch.randn(*s, dtype=torch.bfloat16) * 0.4)(Hq * Dh, D) * (Hq * Dh) ** (-0.5))}
    _A_in = _A_setup()

    def _B_setup():
        B, S, D, F = (4, 1, 512, 1792)
        return {'x': _w((lambda *s: torch.randn(*s, dtype=torch.bfloat16) * 0.05)(B, S, D)), 'w1': _w((lambda *s: torch.randn(*s, dtype=torch.bfloat16) * 0.05)(D, F)), 'b1': _w((lambda *s: torch.randn(*s, dtype=torch.bfloat16) * 0.4)(F)), 'w2': _w((lambda *s: torch.randn(*s, dtype=torch.bfloat16) * 0.05)(F, D)), 'b2': _w((lambda *s: torch.randn(*s, dtype=torch.bfloat16) * 3.2)(D))}
    _B_in = _B_setup()
    return {'A_x': _A_in['x'], 'A_k_cache': _A_in['k_cache'], 'A_v_cache': _A_in['v_cache'], 'A_wq': _A_in['wq'], 'A_wo': _A_in['wo'], 'B_x': _B_in['x'], 'B_w1': _B_in['w1'], 'B_b1': _B_in['b1'], 'B_w2': _B_in['w2'], 'B_b2': _B_in['b2'], 'c': _w((lambda *s: torch.randn(*s, dtype=torch.bfloat16) * 0.1)(4, 512) * 8.0), 'w_mod': _w((lambda *s: torch.randn(*s, dtype=torch.bfloat16) * 0.1)(512, 6 * 512) * 512 ** (-0.5) * 8.0)}

def reference(A_x, A_k_cache, A_v_cache, A_wq, A_wo, B_x, B_w1, B_b1, B_w2, B_b2, c, w_mod):

    def _A_ref(x, k_cache, v_cache, wq, wo):
        B, Sq, D = x.shape
        Hq, Dh = (32, 128)
        Hkv, Sk = (k_cache.shape[1], k_cache.shape[2])
        W = min(4096, max(256, Sk // 4))
        rep = Hq // Hkv
        q = (lambda x, *d: x.permute(*d))((x @ wq).reshape(B, Sq, Hq, Dh), 0, 2, 1, 3)
        k = (lambda x, n, axis: torch.repeat_interleave(x, n, dim=axis))(k_cache[:, :, Sk - W:, :], rep, axis=1)
        v = (lambda x, n, axis: torch.repeat_interleave(x, n, dim=axis))(v_cache[:, :, Sk - W:, :], rep, axis=1)
        scores = torch.einsum('bhqd,bhkd->bhqk', q, k) * Dh ** (-0.5)
        p = _softmax(scores, axis=-1)
        o = torch.einsum('bhqk,bhkd->bhqd', p, v)
        return (lambda x, *d: x.permute(*d))(o, 0, 2, 1, 3).reshape(B, Sq, Hq * Dh) @ wo

    def _B_ref(x, w1, b1, w2, b2):
        h = torch.einsum('bsd,df->bsf', x, w1) + b1
        zero = torch.zeros_like(h)
        r = torch.where(h > zero, h, zero)
        h = r * r
        out = torch.einsum('bsf,fd->bsd', h, w2) + b2
        return out
    x = A_x
    mod = (_silu(c) @ w_mod).reshape(c.shape[0], 6, 1, -1)
    sa, ca, ga, sb, cb, gb = (mod[:, 0].clone(), mod[:, 1].clone(), mod[:, 2].clone(), mod[:, 3].clone(), mod[:, 4].clone(), mod[:, 5].clone())
    h = _layernorm(x, axis=-1) * (1 + ca) + sa
    x = x + ga * _A_ref(h, A_k_cache, A_v_cache, A_wq, A_wo)
    h = _layernorm(x, axis=-1) * (1 + cb) + sb
    x = x + gb * _B_ref(h, B_w1, B_b1, B_w2, B_b2)
    return x
```

```asm
; @launch grid=(256,1,1) block=(512,1,1) lds=163840
.amdgcn_target "amdgcn-amd-amdhsa--gfx950"
.text
.globl adaLN_cond__sliding_block_cached__dense_activation_squared_relu__decode_kernel
.p2align 8
.type adaLN_cond__sliding_block_cached__dense_activation_squared_relu__decode_kernel,@function
adaLN_cond__sliding_block_cached__dense_activation_squared_relu__decode_kernel:
    s_getpc_b64 s[8:9]
    v_lshlrev_b32 v2, 5, v0
    global_load_dword v255, v2, s[8:9]
L_k0:
    s_load_dwordx16 s[16:31], s[0:1], 0
    s_load_dwordx8 s[32:39], s[0:1], 64
    s_load_dwordx4 s[40:43], s[0:1], 96
    s_load_dwordx2 s[44:45], s[0:1], 112
    s_cmp_ge_u32 s2, 0xc0
    s_cbranch_scc1 L_T
    s_bitcmp1_b32 s2, 7
    s_cbranch_scc1 L_W
    v_lshrrev_b32 v1, 6, v0
    s_and_b32 s4, s2, 7
    s_lshr_b32 s5, s2, 3
    v_readfirstlane_b32 s3, v1
    v_and_b32 v1, 63, v0
    v_and_b32 v2, 15, v0
    v_lshrrev_b32 v3, 4, v1
    s_lshl_b32 s14, s3, 14
    s_mov_b32 m0, s14
    s_lshr_b32 s6, s5, 2
    s_and_b32 s7, s5, 3
    s_lshl_b32 s8, s6, 3
    s_add_u32 s8, s8, s4
    s_add_u32 s12, s5, s4
    s_and_b32 s12, s12, 7
    s_lshl_b32 s12, s12, 12
    s_xor_b32 s12, s12, s14
    s_lshl_b32 s8, s8, 21
    s_lshl_b32 s9, s7, 17
    s_add_u32 s8, s8, s9
    s_add_u32 s8, s8, s12
    s_add_u32 s8, s8, 0x180000
    v_lshlrev_b32 v5, 4, v1
    v_lshlrev_b32 v4, 6, v3
    v_xor_b32 v5, v5, v4
    v_xor_b32 v6, 16, v5
    v_xor_b32 v7, 32, v5
    v_xor_b32 v8, 48, v5
    s_waitcnt lgkmcnt(0)
    s_add_u32 s10, s18, s8
    s_addc_u32 s11, s19, 0
    s_load_dword s48, s[44:45], 0
    global_load_lds_dwordx4 v5, s[10:11] offset:0 nt
    global_load_lds_dwordx4 v6, s[10:11] offset:1024 nt
    s_add_u32 s12, s20, s8
    s_addc_u32 s13, s21, 0
    v_lshlrev_b32 v9, 4, v2
    v_lshl_add_u32 v9, v3, 10, v9
    v_mov_b32 v10, 0xff800000
    v_lshrrev_b32 v251, 2, v2
    v_lshlrev_b32 v11, 2, v251
    v_add_u32 v11, 131072, v11
    ds_write_b32 v11, v10
    v_mov_b32 v208, 131072
    v_mov_b32 v209, 1
    v_mov_b32 v210, 0
    v_mov_b32 v211, 0
    ds_write_b64 v208, v[210:211] offset:16
    s_mul_i32 s9, s3, 576
    v_lshl_add_u32 v252, v1, 3, s9
    v_add_u32 v253, 0x10000, v252
    s_mov_b32 s60, 0x07060302
    s_mov_b32 s61, 0x05040100
    s_mov_b32 s62, 0xffff0000
    s_mov_b32 s63, 0xffffff00
    s_mov_b32 s64, 0x3fb8aa3b
    s_getreg_b32 s49, hwreg(HW_REG_XCC_ID, 0, 4)
    s_mov_b32 s50, 0x22222222
    s_mov_b32 s51, 0x22222222
    s_mov_b32 s52, 0x44444444
    s_mov_b32 s53, 0x44444444
    s_mov_b32 s54, 0x88888888
    s_mov_b32 s55, 0x88888888
    s_lshl_b32 s15, s4, 2
    s_add_u32 s15, s15, s6
    s_lshl_b32 s9, s15, 11
    s_add_u32 s9, s9, 65536
    v_lshl_add_u32 v12, v1, 4, s9
    s_lshl_b32 s15, s15, 2
    s_add_u32 s15, s15, s7
    s_lshl_b32 s9, s15, 11
    s_add_u32 s9, s9, 262144
    v_lshl_add_u32 v14, v1, 4, s9
    v_mov_b32 v214, v14
    v_lshl_add_u32 v254, v0, 3, s9
    v_mul_u32_u24 v212, 576, v251
    v_lshl_add_u32 v212, v3, 7, v212
    v_and_b32 v14, 3, v0
    v_lshl_add_u32 v212, v14, 4, v212
    v_add_u32 v212, s14, v212
    v_and_b32 v215, 1, v0
    v_mul_u32_u24 v215, 0xff, v215
    s_mul_i32 s9, s3, 1280
    s_add_u32 s9, s9, 131328
    v_lshrrev_b32 v14, 5, v1
    v_lshlrev_b32 v200, 3, v1
    v_lshl_add_u32 v200, v14, 6, v200
    v_add_u32 v200, s9, v200
    v_mul_u32_u24 v201, 320, v251
    v_lshl_add_u32 v201, v3, 4, v201
    v_add_u32 v201, s9, v201
    s_lshl_b32 s9, s3, 2
    s_add_u32 s9, s9, 131136
    v_lshl_add_u32 v15, v251, 5, s9
    s_waitcnt vmcnt(1)
    global_load_lds_dwordx4 v7, s[10:11] offset:2048 nt
    global_load_lds_dwordx4 v8, s[10:11] offset:3072 nt
    s_xor_b32 s9, s8, 4096
    s_add_u32 s10, s18, s9
    s_addc_u32 s11, s19, 0
    s_add_u32 m0, m0, 0x1000
    s_nop 0
    global_load_lds_dwordx4 v5, s[10:11] offset:0 nt
    global_load_lds_dwordx4 v6, s[10:11] offset:1024 nt
    global_load_lds_dwordx4 v7, s[10:11] offset:2048 nt
    global_load_lds_dwordx4 v8, s[10:11] offset:3072 nt
    s_xor_b32 s9, s8, 8192
    s_add_u32 s10, s18, s9
    s_addc_u32 s11, s19, 0
    s_add_u32 m0, m0, 0x1000
    s_nop 0
    global_load_lds_dwordx4 v5, s[10:11] offset:0 nt
    global_load_lds_dwordx4 v6, s[10:11] offset:1024 nt
    global_load_lds_dwordx4 v7, s[10:11] offset:2048 nt
    global_load_lds_dwordx4 v8, s[10:11] offset:3072 nt
    s_xor_b32 s9, s8, 12288
    s_add_u32 s10, s18, s9
    s_addc_u32 s11, s19, 0
    s_add_u32 m0, m0, 0x1000
    s_nop 0
    global_load_lds_dwordx4 v5, s[10:11] offset:0 nt
    global_load_lds_dwordx4 v6, s[10:11] offset:1024 nt
    global_load_lds_dwordx4 v7, s[10:11] offset:2048 nt
    global_load_lds_dwordx4 v8, s[10:11] offset:3072 nt
    v_xor_b32 v4, v2, v3
    v_lshlrev_b32 v4, 4, v4
    v_and_b32 v5, 3, v2
    v_lshl_add_u32 v4, v5, 10, v4
    v_lshrrev_b32 v5, 2, v2
    v_lshl_add_u32 v5, v5, 8, v4
    v_lshlrev_b32 v9, 4, v1
    v_add_u32 v5, s14, v5
    v_xor_b32 v6, 64, v5
    v_xor_b32 v7, 0x80, v5
    v_xor_b32 v8, 0xc0, v5
    s_waitcnt lgkmcnt(0)
    s_add_u32 s46, s48, 1
    s_and_b32 s46, s46, 0xff
    s_lshl_b32 s47, s46, 8
    s_or_b32 s47, s47, s46
    s_lshl_b32 s67, s49, 8
    s_or_b32 s67, s67, s46
    v_mov_b32 v248, s46
    v_mov_b32 v249, s47
    v_mov_b32 v250, s67
    s_barrier
    global_load_dwordx4 v[64:67], v9, s[12:13] offset:0 nt
    global_load_dwordx4 v[68:71], v9, s[12:13] offset:1024 nt
    global_load_dwordx4 v[72:75], v9, s[12:13] offset:2048 nt
    global_load_dwordx4 v[76:79], v9, s[12:13] offset:3072 nt
    s_xor_b32 s9, s8, 4096
    s_add_u32 s12, s20, s9
    s_addc_u32 s13, s21, 0
    global_load_dwordx4 v[80:83], v9, s[12:13] offset:0 nt
    global_load_dwordx4 v[84:87], v9, s[12:13] offset:1024 nt
    global_load_dwordx4 v[88:91], v9, s[12:13] offset:2048 nt
    global_load_dwordx4 v[92:95], v9, s[12:13] offset:3072 nt
    s_xor_b32 s9, s8, 8192
    s_add_u32 s12, s20, s9
    s_addc_u32 s13, s21, 0
    s_cmp_lg_u32 s3, 7
    s_cbranch_scc1 PF_1
    s_lshl_b32 s9, s15, 7
    s_add_u32 s9, s9, 720960
    v_lshl_add_u32 v213, v2, 2, s9
    s_mov_b64 exec, 15
    global_store_dword v213, v248, s[44:45] sc1
    s_mov_b64 exec, -1
PF_1:
    s_barrier
    global_load_dwordx4 v[192:195], v12, s[44:45] offset:0 sc1
    global_load_dwordx4 v[196:199], v12, s[44:45] offset:1024 sc1
    s_barrier
    s_cmp_lt_u32 s3, 5
    s_cbranch_scc1 L_A_g1
    s_waitcnt vmcnt(10)
    ds_read_b128 v[128:131], v5 offset:0
    ds_read_b128 v[132:135], v6 offset:0
    ds_read_b128 v[136:139], v7 offset:0
    ds_read_b128 v[140:143], v8 offset:0
    ds_read_b128 v[144:147], v5 offset:4096
    ds_read_b128 v[148:151], v6 offset:4096
    ds_read_b128 v[152:155], v7 offset:4096
    ds_read_b128 v[156:159], v8 offset:4096
    ds_read_b128 v[160:163], v5 offset:8192
    ds_read_b128 v[164:167], v6 offset:8192
    ds_read_b128 v[168:171], v7 offset:8192
    ds_read_b128 v[172:175], v8 offset:8192
    ds_read_b128 v[176:179], v5 offset:12288
    ds_read_b128 v[180:183], v6 offset:12288
    ds_read_b128 v[184:187], v7 offset:12288
    ds_read_b128 v[188:191], v8 offset:12288
    s_waitcnt vmcnt(0)
L_A_g1r:
    s_mov_b32 s66, 0
    s_waitcnt vmcnt(63)
Pc_4:
    v_xor_b32 v13, v192, v250
    v_bitop3_b32 v13, v13, v193, v250 bitop3:0xf6
    v_bitop3_b32 v13, v13, v194, v250 bitop3:0xf6
    v_bitop3_b32 v13, v13, v195, v250 bitop3:0xf6
    v_bitop3_b32 v13, v13, v196, v250 bitop3:0xf6
    v_bitop3_b32 v13, v13, v197, v250 bitop3:0xf6
    v_bitop3_b32 v13, v13, v198, v250 bitop3:0xf6
    v_bitop3_b32 v13, v13, v199, v250 bitop3:0xf6
    v_and_b32 v14, 0xff, v13
    v_cmp_ne_u32 vcc, 0, v14
    s_cbranch_vccnz P_2
    v_perm_b32 v202, v193, v192, s60
    v_perm_b32 v203, v195, v194, s60
    v_perm_b32 v204, v197, v196, s60
    v_perm_b32 v205, v199, v198, s60
    ds_write_b64 v200, v[202:203]
    ds_write_b64 v200, v[204:205] offset:640
    v_and_b32 v14, 0xff00, v13
    v_cmp_ne_u32 s[68:69], 0, v14
    s_waitcnt lgkmcnt(0)
    ds_read_b128 v[224:227], v201 offset:0
    ds_read_b128 v[228:231], v201 offset:64
    ds_read_b128 v[232:235], v201 offset:128
    ds_read_b128 v[236:239], v201 offset:192
    s_waitcnt lgkmcnt(3)
    v_mfma_f32_16x16x32_bf16 v[16:19], v[128:131], v[224:227], 0
    v_mfma_f32_16x16x32_bf16 v[20:23], v[144:147], v[224:227], 0
    v_mfma_f32_16x16x32_bf16 v[24:27], v[160:163], v[224:227], 0
    v_mfma_f32_16x16x32_bf16 v[28:31], v[176:179], v[224:227], 0
    s_waitcnt lgkmcnt(2)
    v_mfma_f32_16x16x32_bf16 v[16:19], v[132:135], v[228:231], v[16:19]
    v_mfma_f32_16x16x32_bf16 v[20:23], v[148:151], v[228:231], v[20:23]
    v_mfma_f32_16x16x32_bf16 v[24:27], v[164:167], v[228:231], v[24:27]
    v_mfma_f32_16x16x32_bf16 v[28:31], v[180:183], v[228:231], v[28:31]
    s_waitcnt lgkmcnt(1)
    v_mfma_f32_16x16x32_bf16 v[16:19], v[136:139], v[232:235], v[16:19]
    v_mfma_f32_16x16x32_bf16 v[20:23], v[152:155], v[232:235], v[20:23]
    v_mfma_f32_16x16x32_bf16 v[24:27], v[168:171], v[232:235], v[24:27]
    v_mfma_f32_16x16x32_bf16 v[28:31], v[184:187], v[232:235], v[28:31]
    s_waitcnt lgkmcnt(0)
    v_mfma_f32_16x16x32_bf16 v[16:19], v[140:143], v[236:239], v[16:19]
    v_mfma_f32_16x16x32_bf16 v[20:23], v[156:159], v[236:239], v[20:23]
    v_mfma_f32_16x16x32_bf16 v[24:27], v[172:175], v[236:239], v[24:27]
    v_mfma_f32_16x16x32_bf16 v[28:31], v[188:191], v[236:239], v[28:31]
    s_nop 5
    v_cndmask_b32 v16, v16, v20, s[50:51]
    v_cndmask_b32 v17, v17, v21, s[50:51]
    v_cndmask_b32 v18, v18, v22, s[50:51]
    v_cndmask_b32 v19, v19, v23, s[50:51]
    v_cndmask_b32 v16, v16, v24, s[52:53]
    v_cndmask_b32 v17, v17, v25, s[52:53]
    v_cndmask_b32 v18, v18, v26, s[52:53]
    v_cndmask_b32 v19, v19, v27, s[52:53]
    v_cndmask_b32 v16, v16, v28, s[54:55]
    v_cndmask_b32 v17, v17, v29, s[54:55]
    v_cndmask_b32 v18, v18, v30, s[54:55]
    v_cndmask_b32 v19, v19, v31, s[54:55]
    v_cvt_pk_bf16_f32 v20, v16, v17
    v_lshlrev_b32 v16, 16, v20
    v_and_b32 v17, s62, v20
    v_cvt_pk_bf16_f32 v21, v18, v19
    v_lshlrev_b32 v18, 16, v21
    v_and_b32 v19, s62, v21
    v_mul_f32 v16, 0x3db504f3, v16
    v_mul_f32 v17, 0x3db504f3, v17
    v_mul_f32 v18, 0x3db504f3, v18
    v_mul_f32 v19, 0x3db504f3, v19
    v_cvt_pk_bf16_f32 v20, v16, v17
    v_lshlrev_b32 v16, 16, v20
    v_and_b32 v17, s62, v20
    v_cvt_pk_bf16_f32 v21, v18, v19
    v_lshlrev_b32 v18, 16, v21
    v_and_b32 v19, s62, v21
    v_max3_f32 v206, v16, v17, v18
    v_max_f32 v206, v206, v19
    s_nop 1
    v_max_f32_dpp v206, v206, v206 quad_perm:[1,0,3,2] row_mask:0xf bank_mask:0xf
    s_nop 1
    v_max_f32_dpp v206, v206, v206 quad_perm:[2,3,0,1] row_mask:0xf bank_mask:0xf
    v_mov_b32 v21, v206
    s_nop 1
    v_permlane16_swap_b32 v206, v21
    v_max_f32 v206, v206, v21
    v_mov_b32 v21, v206
    s_nop 1
    v_permlane32_swap_b32 v206, v21
    v_max_f32 v206, v206, v21
    s_mov_b64 exec, 0x1111
    ds_max_f32 v11, v206
    s_mov_b64 exec, 1
    ds_add_u32 v208, v209 offset:16
    s_mov_b64 exec, -1
    s_cmp_lt_u32 s3, 5
    s_cbranch_scc1 LV_6
    global_load_dwordx4 v[96:99], v9, s[12:13] offset:0 nt
    global_load_dwordx4 v[100:103], v9, s[12:13] offset:1024 nt
    global_load_dwordx4 v[104:107], v9, s[12:13] offset:2048 nt
    global_load_dwordx4 v[108:111], v9, s[12:13] offset:3072 nt
    s_xor_b32 s9, s8, 12288
    s_add_u32 s12, s20, s9
    s_addc_u32 s13, s21, 0
    global_load_dwordx4 v[112:115], v9, s[12:13] offset:0 nt
    global_load_dwordx4 v[116:119], v9, s[12:13] offset:1024 nt
    global_load_dwordx4 v[120:123], v9, s[12:13] offset:2048 nt
    global_load_dwordx4 v[124:127], v9, s[12:13] offset:3072 nt
LV_6:
    v_sub_f32 v16, v16, v206
    v_sub_f32 v17, v17, v206
    v_sub_f32 v18, v18, v206
    v_sub_f32 v19, v19, v206
    v_mul_f32 v16, s64, v16
    v_mul_f32 v17, s64, v17
    v_mul_f32 v18, s64, v18
    v_mul_f32 v19, s64, v19
    v_exp_f32 v16, v16
    v_exp_f32 v17, v17
    v_exp_f32 v18, v18
    v_exp_f32 v19, v19
    v_add_f32 v207, v16, v17
    v_add_f32 v21, v18, v19
    v_cvt_pk_bf16_f32 v24, v16, v17
    v_add_f32 v207, v207, v21
    v_cvt_pk_bf16_f32 v25, v18, v19
    s_mov_b32 vcc_lo, 0xeeeeeeee
    s_mov_b32 vcc_hi, 0xeeeeeeee
    v_cndmask_b32_dpp v32, v24, v211, vcc quad_perm:[0,0,0,0] row_mask:0xf bank_mask:0xf
    v_cndmask_b32_dpp v33, v25, v211, vcc quad_perm:[0,0,0,0] row_mask:0xf bank_mask:0xf
    v_cndmask_b32_dpp v34, v24, v211, vcc quad_perm:[1,1,1,1] row_mask:0xf bank_mask:0xf
    v_cndmask_b32_dpp v35, v25, v211, vcc quad_perm:[1,1,1,1] row_mask:0xf bank_mask:0xf
    s_mov_b32 vcc_lo, 0xdddddddd
    s_mov_b32 vcc_hi, 0xdddddddd
    v_cndmask_b32_dpp v36, v24, v211, vcc quad_perm:[0,0,0,0] row_mask:0xf bank_mask:0xf
    v_cndmask_b32_dpp v37, v25, v211, vcc quad_perm:[0,0,0,0] row_mask:0xf bank_mask:0xf
    v_cndmask_b32_dpp v38, v24, v211, vcc quad_perm:[1,1,1,1] row_mask:0xf bank_mask:0xf
    v_cndmask_b32_dpp v39, v25, v211, vcc quad_perm:[1,1,1,1] row_mask:0xf bank_mask:0xf
    s_mov_b32 vcc_lo, 0xbbbbbbbb
    s_mov_b32 vcc_hi, 0xbbbbbbbb
    v_cndmask_b32_dpp v40, v24, v211, vcc quad_perm:[0,0,0,0] row_mask:0xf bank_mask:0xf
    v_cndmask_b32_dpp v41, v25, v211, vcc quad_perm:[0,0,0,0] row_mask:0xf bank_mask:0xf
    v_cndmask_b32_dpp v42, v24, v211, vcc quad_perm:[1,1,1,1] row_mask:0xf bank_mask:0xf
    v_cndmask_b32_dpp v43, v25, v211, vcc quad_perm:[1,1,1,1] row_mask:0xf bank_mask:0xf
    s_mov_b32 vcc_lo, 0x77777777
    s_mov_b32 vcc_hi, 0x77777777
    v_cndmask_b32_dpp v44, v24, v211, vcc quad_perm:[0,0,0,0] row_mask:0xf bank_mask:0xf
    v_cndmask_b32_dpp v45, v25, v211, vcc quad_perm:[0,0,0,0] row_mask:0xf bank_mask:0xf
    v_cndmask_b32_dpp v46, v24, v211, vcc quad_perm:[1,1,1,1] row_mask:0xf bank_mask:0xf
    v_cndmask_b32_dpp v47, v25, v211, vcc quad_perm:[1,1,1,1] row_mask:0xf bank_mask:0xf
    v_add_f32_dpp v207, v207, v207 quad_perm:[1,0,3,2] row_mask:0xf bank_mask:0xf
    s_nop 1
    v_add_f32_dpp v207, v207, v207 quad_perm:[2,3,0,1] row_mask:0xf bank_mask:0xf
    v_mov_b32 v21, v207
    s_nop 1
    v_permlane16_swap_b32 v207, v21
    v_add_f32 v207, v207, v21
    v_mov_b32 v21, v207
    s_nop 1
    v_permlane32_swap_b32 v207, v21
    v_add_f32 v207, v207, v21
    v_perm_b32 v128, v68, v64, s61
    v_perm_b32 v129, v76, v72, s61
    v_perm_b32 v130, v84, v80, s61
    v_perm_b32 v131, v92, v88, s61
    v_perm_b32 v132, v68, v64, s60
    v_perm_b32 v133, v76, v72, s60
    v_perm_b32 v134, v84, v80, s60
    v_perm_b32 v135, v92, v88, s60
    v_mfma_f32_16x16x32_bf16 v[240:243], v[128:131], v[32:35], 0
    v_perm_b32 v136, v69, v65, s61
    v_perm_b32 v137, v77, v73, s61
    v_perm_b32 v138, v85, v81, s61
    v_perm_b32 v139, v93, v89, s61
    v_mfma_f32_16x16x32_bf16 v[240:243], v[132:135], v[36:39], v[240:243]
    v_perm_b32 v140, v69, v65, s60
    v_perm_b32 v141, v77, v73, s60
    v_perm_b32 v142, v85, v81, s60
    v_perm_b32 v143, v93, v89, s60
    v_mfma_f32_16x16x32_bf16 v[240:243], v[136:139], v[40:43], v[240:243]
    v_perm_b32 v144, v70, v66, s61
    v_perm_b32 v145, v78, v74, s61
    v_perm_b32 v146, v86, v82, s61
    v_perm_b32 v147, v94, v90, s61
    v_mfma_f32_16x16x32_bf16 v[240:243], v[140:143], v[44:47], v[240:243]
    v_perm_b32 v148, v70, v66, s60
    v_perm_b32 v149, v78, v74, s60
    v_perm_b32 v150, v86, v82, s60
    v_perm_b32 v151, v94, v90, s60
    v_mfma_f32_16x16x32_bf16 v[244:247], v[144:147], v[32:35], 0
    v_perm_b32 v152, v71, v67, s61
    v_perm_b32 v153, v79, v75, s61
    v_perm_b32 v154, v87, v83, s61
    v_perm_b32 v155, v95, v91, s61
    v_mfma_f32_16x16x32_bf16 v[244:247], v[148:151], v[36:39], v[244:247]
    v_perm_b32 v156, v71, v67, s60
    v_perm_b32 v157, v79, v75, s60
    v_perm_b32 v158, v87, v83, s60
    v_perm_b32 v159, v95, v91, s60
    v_mfma_f32_16x16x32_bf16 v[244:247], v[152:155], v[40:43], v[244:247]
    s_nop 0
    v_mfma_f32_16x16x32_bf16 v[244:247], v[156:159], v[44:47], v[244:247]
    s_mov_b32 s66, 0
L_A_sp:
    ds_read_b32 v26, v208 offset:16
    ds_read_b32 v27, v11
    s_add_u32 s66, s66, 1
    s_cmp_gt_u32 s66, 8388608
    s_cbranch_scc1 L_end
    s_waitcnt lgkmcnt(0)
    v_cmp_gt_u32 vcc, 8, v26
    s_cbranch_vccnz L_A_sp
    v_sub_f32 v210, v206, v27
    v_mul_f32 v210, s64, v210
    v_exp_f32 v210, v210
    s_nop 0
    v_mul_f32 v207, v207, v210
    s_mov_b64 exec, 0x1111
    ds_write_b32 v15, v207
    s_mov_b64 exec, 1
    ds_add_rtn_u32 v28, v208, v209 offset:20
    s_mov_b64 exec, -1
    v_pk_mul_f32 v[16:17], v[16:17], v[210:211] op_sel_hi:[1,0]
    v_pk_mul_f32 v[18:19], v[18:19], v[210:211] op_sel_hi:[1,0]
    v_cvt_pk_bf16_f32 v24, v16, v17
    v_cvt_pk_bf16_f32 v25, v18, v19
    v_pk_mul_f32 v[240:241], v[240:241], v[210:211] op_sel_hi:[1,0]
    v_pk_mul_f32 v[242:243], v[242:243], v[210:211] op_sel_hi:[1,0]
    v_pk_mul_f32 v[244:245], v[244:245], v[210:211] op_sel_hi:[1,0]
    v_pk_mul_f32 v[246:247], v[246:247], v[210:211] op_sel_hi:[1,0]
    s_mov_b32 vcc_lo, 0xeeeeeeee
    s_mov_b32 vcc_hi, 0xeeeeeeee
    v_cndmask_b32_dpp v48, v24, v211, vcc quad_perm:[2,2,2,2] row_mask:0xf bank_mask:0xf
    v_cndmask_b32_dpp v49, v25, v211, vcc quad_perm:[2,2,2,2] row_mask:0xf bank_mask:0xf
    v_cndmask_b32_dpp v50, v24, v211, vcc quad_perm:[3,3,3,3] row_mask:0xf bank_mask:0xf
    v_cndmask_b32_dpp v51, v25, v211, vcc quad_perm:[3,3,3,3] row_mask:0xf bank_mask:0xf
    s_mov_b32 vcc_lo, 0xdddddddd
    s_mov_b32 vcc_hi, 0xdddddddd
    v_cndmask_b32_dpp v52, v24, v211, vcc quad_perm:[2,2,2,2] row_mask:0xf bank_mask:0xf
    v_cndmask_b32_dpp v53, v25, v211, vcc quad_perm:[2,2,2,2] row_mask:0xf bank_mask:0xf
    v_cndmask_b32_dpp v54, v24, v211, vcc quad_perm:[3,3,3,3] row_mask:0xf bank_mask:0xf
    v_cndmask_b32_dpp v55, v25, v211, vcc quad_perm:[3,3,3,3] row_mask:0xf bank_mask:0xf
    s_mov_b32 vcc_lo, 0xbbbbbbbb
    s_mov_b32 vcc_hi, 0xbbbbbbbb
    v_cndmask_b32_dpp v56, v24, v211, vcc quad_perm:[2,2,2,2] row_mask:0xf bank_mask:0xf
    v_cndmask_b32_dpp v57, v25, v211, vcc quad_perm:[2,2,2,2] row_mask:0xf bank_mask:0xf
    v_cndmask_b32_dpp v58, v24, v211, vcc quad_perm:[3,3,3,3] row_mask:0xf bank_mask:0xf
    v_cndmask_b32_dpp v59, v25, v211, vcc quad_perm:[3,3,3,3] row_mask:0xf bank_mask:0xf
    s_mov_b32 vcc_lo, 0x77777777
    s_mov_b32 vcc_hi, 0x77777777
    v_cndmask_b32_dpp v60, v24, v211, vcc quad_perm:[2,2,2,2] row_mask:0xf bank_mask:0xf
    v_cndmask_b32_dpp v61, v25, v211, vcc quad_perm:[2,2,2,2] row_mask:0xf bank_mask:0xf
    v_cndmask_b32_dpp v62, v24, v211, vcc quad_perm:[3,3,3,3] row_mask:0xf bank_mask:0xf
    v_cndmask_b32_dpp v63, v25, v211, vcc quad_perm:[3,3,3,3] row_mask:0xf bank_mask:0xf
    s_waitcnt lgkmcnt(0)
    v_readfirstlane_b32 s9, v28
    s_cmp_eq_u32 s9, 7
    s_cbranch_scc1 L_A_ml
    s_waitcnt vmcnt(6)
    v_perm_b32 v160, v100, v96, s61
    v_perm_b32 v164, v100, v96, s60
    v_perm_b32 v168, v101, v97, s61
    v_perm_b32 v172, v101, v97, s60
    v_perm_b32 v176, v102, v98, s61
    v_perm_b32 v180, v102, v98, s60
    v_perm_b32 v184, v103, v99, s61
    v_perm_b32 v188, v103, v99, s60
    s_waitcnt vmcnt(4)
    v_perm_b32 v161, v108, v104, s61
    v_perm_b32 v165, v108, v104, s60
    v_perm_b32 v169, v109, v105, s61
    v_perm_b32 v173, v109, v105, s60
    v_perm_b32 v177, v110, v106, s61
    v_perm_b32 v181, v110, v106, s60
    v_perm_b32 v185, v111, v107, s61
    v_perm_b32 v189, v111, v107, s60
    s_waitcnt vmcnt(2)
    v_perm_b32 v162, v116, v112, s61
    v_perm_b32 v166, v116, v112, s60
    v_perm_b32 v170, v117, v113, s61
    v_perm_b32 v174, v117, v113, s60
    v_perm_b32 v178, v118, v114, s61
    v_perm_b32 v182, v118, v114, s60
    v_perm_b32 v186, v119, v115, s61
    v_perm_b32 v190, v119, v115, s60
    s_waitcnt vmcnt(0)
L_A_pv1:
    v_perm_b32 v163, v124, v120, s61
    v_perm_b32 v167, v124, v120, s60
    v_perm_b32 v171, v125, v121, s61
    v_perm_b32 v175, v125, v121, s60
    v_mfma_f32_16x16x32_bf16 v[240:243], v[160:163], v[48:51], v[240:243]
    v_perm_b32 v179, v126, v122, s61
    v_perm_b32 v183, v126, v122, s60
    v_mfma_f32_16x16x32_bf16 v[240:243], v[164:167], v[52:55], v[240:243]
    v_perm_b32 v187, v127, v123, s61
    v_perm_b32 v191, v127, v123, s60
    v_mfma_f32_16x16x32_bf16 v[240:243], v[168:171], v[56:59], v[240:243]
    v_mfma_f32_16x16x32_bf16 v[240:243], v[172:175], v[60:63], v[240:243]
    v_mfma_f32_16x16x32_bf16 v[244:247], v[176:179], v[48:51], v[244:247]
    v_mfma_f32_16x16x32_bf16 v[244:247], v[180:183], v[52:55], v[244:247]
    v_mfma_f32_16x16x32_bf16 v[244:247], v[184:187], v[56:59], v[244:247]
    v_mfma_f32_16x16x32_bf16 v[244:247], v[188:191], v[60:63], v[244:247]
    s_cmp_ge_u32 s3, 4
    s_nop 2
    ds_write_b128 v212, v[240:243]
    s_nop 2
    ds_write_b128 v212, v[244:247] offset:64
    s_waitcnt lgkmcnt(0)
    s_barrier
    s_cbranch_scc1 L_end
    ds_read_b64 v[16:17], v252 offset:0
    ds_read_b64 v[18:19], v252 offset:16384
    ds_read_b64 v[20:21], v252 offset:32768
    ds_read_b64 v[22:23], v252 offset:49152
    ds_read_b64 v[24:25], v253 offset:0
    ds_read_b64 v[26:27], v253 offset:16384
    ds_read_b64 v[28:29], v253 offset:32768
    ds_read_b64 v[30:31], v253 offset:49152
    s_waitcnt lgkmcnt(6)
    v_pk_add_f32 v[16:17], v[16:17], v[18:19]
    s_waitcnt lgkmcnt(4)
    v_pk_add_f32 v[20:21], v[20:21], v[22:23]
    s_waitcnt lgkmcnt(2)
    v_pk_add_f32 v[24:25], v[24:25], v[26:27]
    v_pk_add_f32 v[16:17], v[16:17], v[20:21]
    v_pk_add_f32 v[16:17], v[16:17], v[24:25]
    s_waitcnt lgkmcnt(0)
    v_pk_add_f32 v[28:29], v[28:29], v[30:31]
    v_pk_add_f32 v[16:17], v[16:17], v[28:29]
    v_bfi_b32 v17, v215, v248, v17
    global_store_dwordx2 v254, v[16:17], s[44:45]
    v_add_u32 v254, 524288, v254
    global_store_dwordx2 v254, v[16:17], s[44:45] sc1
L_A_pub3:
    s_cmp_lg_u32 s3, 0
    s_cbranch_scc1 L_end
    s_bfe_u32 s10, s2, 0x10003
    s_lshr_b32 s11, s2, 4
    s_lshl_b32 s11, s11, 3
    s_add_u32 s11, s11, s4
    s_lshr_b32 s6, s11, 5
    s_lshl_b32 s6, s6, 1
    s_add_u32 s6, s6, s10
    s_bfe_u32 s7, s11, 0x30002
    s_and_b32 s8, s11, 3
    s_lshl_b32 s8, s8, 4
    s_lshl_b32 s9, s7, 6
    s_add_u32 s8, s8, s9
    v_and_b32 v9, 7, v1
    v_lshlrev_b32 v4, 1, v9
    v_lshrrev_b32 v5, 5, v1
    v_add3_u32 v4, v4, v5, s8
    s_lshl_b32 s9, s6, 10
    v_lshlrev_b32 v5, 1, v4
    v_add_u32 v6, s9, v5
    global_load_ushort v20, v6, s[16:17]
    global_load_ushort v21, v5, s[34:35]
    s_lshl_b32 s9, s6, 13
    s_add_u32 s9, s9, 16384
    v_lshl_add_u32 v7, v4, 2, s9
    v_add_u32 v8, 6144, v7
    s_mov_b32 s66, 0
P_7:
    s_add_u32 s66, s66, 1
    s_cmp_gt_u32 s66, 1048576
    s_cbranch_scc1 L_end
Pq_8:
    global_load_dword v22, v7, s[44:45] sc1
    global_load_dword v23, v8, s[44:45] sc1
    s_waitcnt vmcnt(0)
    v_xor_b32 v13, v22, v249
    v_bitop3_b32 v13, v13, v23, v249 bitop3:0xf6
    v_and_b32 v14, 0xffff, v13
    v_cmp_ne_u32 vcc, 0, v14
    s_cbranch_vccnz P_7
    s_lshl_b32 s9, s6, 3
    s_add_u32 s9, s9, s7
    s_lshl_b32 s9, s9, 11
    s_add_u32 s9, s9, 1048576
    v_and_b32 v7, 60, v4
    v_lshlrev_b32 v7, 2, v7
    v_bfe_u32 v8, v1, 3, 2
    v_lshl_add_u32 v7, v8, 9, v7
    v_add_u32 v7, s9, v7
    s_mul_i32 s9, s11, 3584
    s_lshl_b32 s10, s10, 6
    s_add_u32 s9, s9, s10
    s_add_u32 s9, s9, 1114112
    v_lshrrev_b32 v8, 3, v1
    v_lshlrev_b32 v8, 7, v8
    v_lshl_add_u32 v9, v9, 3, v8
    v_add_u32 v9, s9, v9
    v_lshlrev_b32 v20, 16, v20
    v_lshlrev_b32 v21, 16, v21
    v_and_b32 v22, s62, v22
    v_and_b32 v23, s62, v23
    s_mov_b32 s56, 0xff
    s_mov_b32 s57, 0xff
    v_mov_b32 v44, 0
    v_mov_b32 v45, 0
    v_mov_b32 v46, 0
    v_mov_b32 v47, v248
    s_mov_b32 s66, 0
P_11:
    s_add_u32 s66, s66, 1
    s_cmp_gt_u32 s66, 1048576
    s_cbranch_scc1 L_end
Pq_12:
    s_sleep 8
    global_load_dwordx4 v[24:27], v7, s[44:45] sc1
    global_load_dwordx4 v[28:31], v7, s[44:45] offset:256 sc1
    s_waitcnt vmcnt(0)
    v_xor_b32 v13, v27, v248
    v_bitop3_b32 v13, v13, v31, v248 bitop3:0xf6
    v_and_b32 v14, 0xff, v13
    v_cmp_ne_u32 vcc, 0, v14
    s_cbranch_vccnz P_11
    v_and_b32 v27, s63, v27
    v_and_b32 v31, s63, v31
    v_pk_add_f32 v[24:25], v[24:25], v[28:29]
    v_pk_add_f32 v[26:27], v[26:27], v[30:31]
    s_mov_b32 s12, 0
    s_mov_b32 s13, -1
    v_cndmask_b32 v24, v24, v25, s[12:13]
    v_cndmask_b32 v26, v26, v27, s[12:13]
    s_mov_b32 s12, 0xaaaaaaaa
    s_mov_b32 s13, 0xaaaaaaaa
    v_cndmask_b32 v24, v24, v26, s[12:13]
    s_nop 1
    v_add_f32_dpp v24, v24, v24 row_ror:8 row_mask:0xf bank_mask:0xf
    v_mov_b32 v25, v24
    s_nop 1
    v_permlane16_swap_b32 v24, v25
    v_add_f32 v24, v24, v25
    v_cvt_pk_bf16_f32 v24, v24, v24
    v_and_b32 v24, s62, v24
    v_mul_f32 v24, v22, v24
    v_cvt_pk_bf16_f32 v24, v24, v24
    v_and_b32 v24, s62, v24
    v_add_f32 v24, v20, v24
    v_cvt_pk_bf16_f32 v24, v24, v24
    v_and_b32 v24, s62, v24
    s_mov_b32 s58, -1
    s_mov_b32 s59, 0
    v_mov_b32 v48, 0
    v_mov_b32 v49, 0
    global_atomic_add_x2 v[40:41], v9, v[48:49], s[44:45] offset:0 sc0 sc1
    global_atomic_add_x2 v[42:43], v9, v[48:49], s[44:45] offset:1024 sc0 sc1
    global_atomic_add_x2 v[44:45], v9, v[48:49], s[44:45] offset:2048 sc0 sc1
    s_mov_b64 exec, s[58:59]
    global_atomic_add_x2 v[46:47], v9, v[48:49], s[44:45] offset:3072 sc0 sc1
    s_mov_b64 exec, -1
    s_mov_b32 s66, 0
    s_waitcnt vmcnt(0)
    s_branch Gc_16
G_15:
    s_wqm_b64 exec, s[6:7]
    global_atomic_add_x2 v[40:41], v9, v[48:49], s[44:45] offset:0 sc0 sc1
    s_wqm_b64 exec, s[8:9]
    global_atomic_add_x2 v[42:43], v9, v[48:49], s[44:45] offset:1024 sc0 sc1
    s_wqm_b64 exec, s[10:11]
    global_atomic_add_x2 v[44:45], v9, v[48:49], s[44:45] offset:2048 sc0 sc1
    s_wqm_b64 exec, s[12:13]
    global_atomic_add_x2 v[46:47], v9, v[48:49], s[44:45] offset:3072 sc0 sc1
    s_mov_b64 exec, -1
    s_add_u32 s66, s66, 1
    s_cmp_gt_u32 s66, 1048576
    s_cbranch_scc1 L_end
    s_waitcnt vmcnt(0)
Gc_16:
    v_cmp_ne_u32_sdwa s[6:7], v41, v248 src0_sel:BYTE_0 src1_sel:BYTE_0
    v_cmp_ne_u32_sdwa s[8:9], v43, v248 src0_sel:BYTE_0 src1_sel:BYTE_0
    v_cmp_ne_u32_sdwa s[10:11], v45, v248 src0_sel:BYTE_0 src1_sel:BYTE_0
    v_cmp_ne_u32_sdwa s[12:13], v47, v248 src0_sel:BYTE_0 src1_sel:BYTE_0
    s_or_b64 vcc, s[6:7], s[8:9]
    s_or_b64 vcc, vcc, s[10:11]
    s_or_b64 vcc, vcc, s[12:13]
    s_cbranch_scc1 G_15
    v_and_b32 v33, s63, v41
    v_and_b32 v35, s63, v43
    v_add_f32 v32, v40, v42
    v_and_b32 v37, s63, v45
    v_and_b32 v39, s63, v47
    v_add_f32 v34, v44, v46
    v_add_f32 v33, v33, v35
    v_add_f32 v37, v37, v39
    v_add_f32 v32, v32, v34
    v_add_f32 v33, v33, v37
    s_nop 1
    v_permlane32_swap_b32 v32, v33
    v_add_f32 v32, v32, v33
    v_mov_b32 v33, v32
    s_nop 1
    v_permlane16_swap_b32 v32, v33
    v_add_f32 v32, v32, v33
    s_nop 1
    v_add_f32_dpp v32, v32, v32 row_ror:8 row_mask:0xf bank_mask:0xf
    v_cvt_pk_bf16_f32 v32, v32, v32
    v_and_b32 v32, s62, v32
    v_add_f32 v32, v32, v21
    v_cvt_pk_bf16_f32 v32, v32, v32
    v_and_b32 v32, s62, v32
    v_mul_f32 v32, v23, v32
    v_cvt_pk_bf16_f32 v32, v32, v32
    v_and_b32 v32, s62, v32
    v_add_f32 v32, v24, v32
    v_cvt_pk_bf16_f32 v32, v32, v32
    s_mov_b64 exec, s[56:57]
    global_store_short v6, v32, s[40:41]
    s_endpgm
    .p2align 6
L_T:
    s_cmp_ge_u32 s2, 0x100
    s_cbranch_scc1 L_exit
    v_lshrrev_b32 v1, 6, v0
    s_and_b32 s4, s2, 7
    s_lshr_b32 s5, s2, 3
    v_readfirstlane_b32 s3, v1
    v_and_b32 v1, 63, v0
    v_and_b32 v2, 15, v0
    v_lshrrev_b32 v3, 4, v1
    s_lshl_b32 s14, s3, 14
    s_mov_b32 m0, s14
    s_sub_u32 s5, s5, 16
    v_and_b32 v6, 1, v3
    v_xor_b32 v6, v6, v1
    v_and_b32 v6, 7, v6
    v_lshlrev_b32 v6, 4, v6
    v_bfe_u32 v7, v1, 3, 2
    v_lshrrev_b32 v9, 5, v1
    v_lshl_add_u32 v4, v9, 4, v7
    v_lshrrev_b32 v11, 2, v2
    v_and_b32 v12, 3, v1
    v_lshlrev_b32 v10, 2, v12
    v_lshl_add_u32 v10, v3, 4, v10
    v_lshlrev_b32 v13, 10, v11
    v_lshl_add_u32 v13, v10, 1, v13
    s_lshl_b32 s6, s3, 7
    v_add_u32 v13, s6, v13
    s_sub_u32 s5, s5, 8
    s_movk_i32 s7, 6144
    v_mad_u32_u24 v8, v4, s7, v6
    s_and_b32 s6, s5, 1
    s_lshl_b32 s6, s6, 10
    s_lshl_b32 s7, s4, 7
    s_add_u32 s6, s6, s7
    s_lshl_b32 s7, s5, 3
    s_xor_b32 s8, s4, 3
    s_add_u32 s7, s7, s8
    s_lshl_b32 s7, s7, 7
    s_sub_u32 s7, s7, 2048
    s_and_b32 s8, s5, 2
    s_cmp_lt_u32 s5, 4
    s_cselect_b32 s15, s6, s7
    s_cselect_b32 s8, s8, 0
    s_lshl_b32 s9, s8, 3
    v_xor_b32 v13, s9, v13
    s_lshl_b32 s8, s8, 2
    s_lshl_b32 s9, s3, 6
    s_add_u32 s8, s8, s9
    s_mul_i32 s8, s8, 6144
    s_add_u32 s8, s8, s15
    s_waitcnt lgkmcnt(0)
    s_load_dword s48, s[44:45], 0
    global_load_dwordx2 v[16:17], v13, s[36:37]
    s_add_u32 s10, s38, s8
    s_addc_u32 s11, s39, 0
    s_cmp_lt_u32 s5, 4
    s_cbranch_scc1 L_F_pf
    s_and_b32 s8, s5, 2
    s_lshl_b32 s8, s8, 2
    s_lshl_b32 s9, s3, 5
    s_add_u32 s8, s8, s9
    s_add_u32 s8, s8, 256
    s_mul_i32 s8, s8, 6144
    s_add_u32 s8, s8, s6
    v_lshrrev_b32 v20, 3, v1
    v_mul_u32_u24 v20, 6144, v20
    v_and_b32 v21, 7, v1
    v_lshl_add_u32 v20, v21, 4, v20
    v_add_u32 v20, s8, v20
    global_load_dwordx4 v[240:243], v20, s[38:39]
    v_add_u32 v20, 98304, v20
    global_load_dwordx4 v[240:243], v20, s[38:39]
    s_waitcnt vmcnt(0)
    s_barrier
L_F_pf:
    global_load_lds_dwordx4 v8, s[10:11] offset:0 nt
    v_add_u32 v15, 195584, v8
    global_load_lds_dwordx4 v15, s[10:11] offset:1024 nt
    v_add_u32 v15, 22528, v8
    global_load_lds_dwordx4 v15, s[10:11] offset:2048 nt
    v_add_u32 v15, 218112, v8
    global_load_lds_dwordx4 v15, s[10:11] offset:3072 nt
    s_cmp_lt_u32 s5, 4
    s_cbranch_scc1 L_F_d1
    s_add_u32 m0, m0, 0x1000
    v_add_u32 v15, 49152, v8
    global_load_lds_dwordx4 v15, s[10:11] offset:0 nt
    v_add_u32 v15, 244736, v8
    global_load_lds_dwordx4 v15, s[10:11] offset:1024 nt
    v_add_u32 v15, 71680, v8
    global_load_lds_dwordx4 v15, s[10:11] offset:2048 nt
    v_add_u32 v15, 267264, v8
    global_load_lds_dwordx4 v15, s[10:11] offset:3072 nt
L_F_d1:
    s_mov_b32 s60, 0x07060302
    s_mov_b32 s61, 0x05040100
    s_mov_b32 s62, 0xffff0000
    s_mov_b32 s63, 0xffffff00
    s_mov_b32 s64, 0x3fb8aa3b
    s_getreg_b32 s49, hwreg(HW_REG_XCC_ID, 0, 4)
    s_mov_b32 s50, 0x22222222
    s_mov_b32 s51, 0x22222222
    s_mov_b32 s52, 0x44444444
    s_mov_b32 s53, 0x44444444
    s_mov_b32 s54, 0x88888888
    s_mov_b32 s55, 0x88888888
    s_mov_b32 s58, 0x00ff00ff
    s_mov_b32 s59, 0x00ff00ff
    v_lshrrev_b32 v15, 2, v1
    v_lshl_add_u32 v18, v12, 5, s14
    v_lshl_add_u32 v26, v15, 7, v18
    v_bfe_u32 v19, v1, 3, 1
    v_lshl_add_u32 v26, v19, 4, v26
    v_xor_b32 v27, 8, v26
    v_xor_b32 v28, 16, v26
    v_xor_b32 v29, 24, v26
    s_mul_i32 s6, s3, 1280
    s_add_u32 s6, s6, 131072
    v_mul_u32_u24 v31, 320, v3
    v_lshl_add_u32 v30, v2, 4, v31
    v_add_u32 v30, s6, v30
    s_lshl_b32 s6, s3, 6
    s_add_u32 s6, s6, 131072
    v_lshl_add_u32 v31, v2, 2, v31
    v_add_u32 v31, s6, v31
    s_waitcnt vmcnt(4)
    v_lshlrev_b32 v40, 16, v16
    v_and_b32 v41, s62, v16
    v_lshlrev_b32 v42, 16, v17
    v_and_b32 v43, s62, v17
    v_mul_f32 v44, s64, v40
    v_mul_f32 v45, s64, v41
    v_mul_f32 v46, s64, v42
    v_mul_f32 v47, s64, v43
    v_exp_f32 v44, -v44
    v_exp_f32 v45, -v45
    v_exp_f32 v46, -v46
    v_exp_f32 v47, -v47
    v_add_f32 v44, 1.0, v44
    v_add_f32 v45, 1.0, v45
    v_add_f32 v46, 1.0, v46
    v_add_f32 v47, 1.0, v47
    v_rcp_f32 v44, v44
    v_rcp_f32 v45, v45
    v_rcp_f32 v46, v46
    v_rcp_f32 v47, v47
    v_mul_f32 v40, v40, v44
    v_mul_f32 v41, v41, v45
    v_mul_f32 v42, v42, v46
    v_mul_f32 v43, v43, v47
    v_cvt_pk_bf16_f32 v16, v40, v41
    v_cvt_pk_bf16_f32 v17, v42, v43
    s_nop 0
    v_mov_b32_dpp v96, v16 quad_perm:[0,0,0,0] row_mask:0xf bank_mask:0xf
    v_mov_b32_dpp v97, v17 quad_perm:[0,0,0,0] row_mask:0xf bank_mask:0xf
    v_mov_b32_dpp v98, v16 quad_perm:[1,1,1,1] row_mask:0xf bank_mask:0xf
    v_mov_b32_dpp v99, v17 quad_perm:[1,1,1,1] row_mask:0xf bank_mask:0xf
    v_mov_b32_dpp v100, v16 quad_perm:[2,2,2,2] row_mask:0xf bank_mask:0xf
    v_mov_b32_dpp v101, v17 quad_perm:[2,2,2,2] row_mask:0xf bank_mask:0xf
    v_mov_b32_dpp v102, v16 quad_perm:[3,3,3,3] row_mask:0xf bank_mask:0xf
    v_mov_b32_dpp v103, v17 quad_perm:[3,3,3,3] row_mask:0xf bank_mask:0xf
    s_and_b32 s6, s5, 1
    s_lshl_b32 s6, s6, 1
    s_lshr_b32 s7, s5, 1
    s_add_u32 s6, s6, s7
    s_lshl_b32 s6, s6, 10
    s_lshl_b32 s7, s4, 12
    s_add_u32 s6, s6, s7
    s_add_u32 s6, s6, 131072
    v_lshl_add_u32 v50, v0, 2, s6
    s_lshl_b32 s6, s15, 1
    s_lshl_b32 s7, s3, 13
    s_add_u32 s6, s6, s7
    s_add_u32 s6, s6, 12288
    v_lshl_add_u32 v51, v1, 2, s6
    s_waitcnt lgkmcnt(0)
    s_add_u32 s46, s48, 1
    s_and_b32 s46, s46, 0xff
    s_lshl_b32 s47, s46, 8
    s_or_b32 s47, s47, s46
    s_lshl_b32 s67, s49, 8
    s_or_b32 s67, s67, s46
    v_mov_b32 v248, s46
    v_mov_b32 v249, s47
    v_mov_b32 v250, s67
    s_waitcnt vmcnt(0)
    ds_read_b64_tr_b16 v[128:129], v26 offset:0
    ds_read_b64_tr_b16 v[130:131], v26 offset:2048
    ds_read_b64_tr_b16 v[132:133], v27 offset:0
    ds_read_b64_tr_b16 v[134:135], v27 offset:2048
    ds_read_b64_tr_b16 v[136:137], v28 offset:0
    ds_read_b64_tr_b16 v[138:139], v28 offset:2048
    ds_read_b64_tr_b16 v[140:141], v29 offset:0
    ds_read_b64_tr_b16 v[142:143], v29 offset:2048
    s_waitcnt lgkmcnt(0)
    v_mfma_f32_16x16x32_bf16 v[104:107], v[128:131], v[96:99], 0
    v_mfma_f32_16x16x32_bf16 v[108:111], v[132:135], v[96:99], 0
    v_mfma_f32_16x16x32_bf16 v[112:115], v[136:139], v[96:99], 0
    v_mfma_f32_16x16x32_bf16 v[116:119], v[140:143], v[96:99], 0
    s_cmp_ge_u32 s5, 4
    s_cbranch_scc1 L_F_m2
L_F_m1:
    s_nop 4
    v_cndmask_b32 v104, v104, v108, s[50:51]
    v_cndmask_b32 v105, v105, v109, s[50:51]
    v_cndmask_b32 v106, v106, v110, s[50:51]
    v_cndmask_b32 v107, v107, v111, s[50:51]
    v_cndmask_b32 v104, v104, v112, s[52:53]
    v_cndmask_b32 v105, v105, v113, s[52:53]
    v_cndmask_b32 v106, v106, v114, s[52:53]
    v_cndmask_b32 v107, v107, v115, s[52:53]
    v_cndmask_b32 v104, v104, v116, s[54:55]
    v_cndmask_b32 v105, v105, v117, s[54:55]
    v_cndmask_b32 v106, v106, v118, s[54:55]
    v_cndmask_b32 v107, v107, v119, s[54:55]
    s_cmp_ge_u32 s3, 4
    ds_write_b128 v30, v[104:107]
    s_waitcnt lgkmcnt(0)
    s_barrier
    s_cbranch_scc1 L_F_m3
    ds_read2st64_b32 v[64:65], v31 offset0:0 offset1:5
    ds_read2st64_b32 v[66:67], v31 offset0:10 offset1:15
    ds_read2st64_b32 v[68:69], v31 offset0:20 offset1:25
    ds_read2st64_b32 v[70:71], v31 offset0:30 offset1:35
    s_waitcnt lgkmcnt(2)
    v_pk_add_f32 v[64:65], v[64:65], v[66:67]
    s_waitcnt lgkmcnt(0)
    v_pk_add_f32 v[68:69], v[68:69], v[70:71]
    v_pk_add_f32 v[64:65], v[64:65], v[68:69]
    v_add_f32 v64, v64, v65
    s_cmp_ge_u32 s5, 4
    s_cbranch_scc1 L_F_late
    v_bfi_b32 v64, 3, v248, v64
    global_store_dword v50, v64, s[44:45] sc1
L_F_m3:
    s_cmp_ge_u32 s5, 4
    s_cbranch_scc1 L_F_nt
    s_barrier
    s_lshl_b32 s6, s4, 15
    s_lshl_b32 s7, s5, 13
    s_add_u32 s6, s6, s7
    s_add_u32 s6, s6, 262144
    v_lshl_add_u32 v20, v0, 4, s6
    s_lshl_b32 s6, s4, 13
    s_lshl_b32 s7, s5, 11
    s_add_u32 s6, s6, s7
    s_add_u32 s6, s6, 65536
    v_lshl_add_u32 v21, v0, 2, s6
    global_load_dword v240, v21, s[44:45] sc1
    global_load_dwordx4 v[240:243], v20, s[44:45] sc1
L_F_nt:
    s_cmp_eq_u32 s4, 0
    s_cbranch_scc1 L_F_spare
    s_lshr_b32 s70, s5, 2
    s_and_b32 s15, s5, 3
    s_xor_b32 s6, s4, 7
    s_lshl_b32 s6, s6, 2
    s_add_u32 s15, s15, s6
    s_movk_i32 s7, 3584
    v_mad_u32_u24 v8, v4, s7, v6
    v_lshl_add_u32 v7, v4, 10, v6
    s_mul_i32 s6, s3, 229376
    s_lshl_b32 s7, s15, 7
    s_add_u32 s6, s6, s7
    s_add_u32 s10, s28, s6
    s_addc_u32 s11, s29, 0
    s_lshl_b32 s6, s15, 16
    s_lshl_b32 s7, s3, 7
    s_add_u32 s6, s6, s7
    s_add_u32 s12, s32, s6
    s_addc_u32 s13, s33, 0
    s_add_u32 m0, s14, 8192
    s_barrier
    v_bfe_u32 v43, v1, 2, 1
    v_bfe_u32 v42, v1, 3, 1
    s_lshl_b32 s6, s3, 6
    v_add_u32 v40, s6, v10
    s_lshl_b32 s8, s70, 11
    v_lshl_add_u32 v44, v43, 10, s8
    v_lshl_add_u32 v41, v40, 1, v44
    global_load_dwordx2 v[16:17], v41, s[16:17]
    global_load_dwordx2 v[22:23], v44, s[16:17]
    s_lshl_b32 s8, s70, 14
    s_add_u32 s8, s8, 18432
    v_lshlrev_b32 v41, 13, v43
    v_lshl_add_u32 v41, v40, 2, v41
    v_add_u32 v41, s8, v41
    s_lshl_b32 s8, s70, 15
    s_lshl_b32 s9, s3, 11
    s_add_u32 s8, s8, s9
    s_add_u32 s8, s8, 1048576
    v_lshlrev_b32 v212, 14, v43
    v_lshl_add_u32 v212, v42, 8, v212
    v_lshl_add_u32 v212, v10, 2, v212
    v_add_u32 v212, s8, v212
    v_and_b32 v46, 0x38, v1
    v_lshl_add_u32 v46, v12, 1, v46
    s_lshl_b32 s8, s15, 7
    v_lshl_add_u32 v47, v46, 1, s8
    global_load_dword v18, v47, s[30:31]
    v_mul_u32_u24 v213, 320, v3
    v_lshl_add_u32 v213, v43, 6, v213
    v_and_b32 v47, 15, v46
    v_lshl_add_u32 v213, v47, 2, v213
    v_add_u32 v213, 131072, v213
    v_lshlrev_b32 v214, 6, v43
    v_add_u32 v214, 141952, v214
    v_lshl_add_u32 v215, v42, 5, v214
    v_lshl_add_u32 v215, v12, 3, v215
    s_lshl_b32 s7, s3, 3
    v_and_b32 v217, 1, v3
    v_lshl_add_u32 v217, v217, 2, v214
    v_add_u32 v217, s7, v217
    s_lshl_b32 s8, s70, 5
    s_lshl_b32 s9, s3, 2
    s_add_u32 s8, s8, s9
    s_mul_i32 s8, s8, 28
    s_add_u32 s8, s8, s15
    s_lshl_b32 s8, s8, 7
    s_add_u32 s8, s8, 1114112
    v_and_b32 v47, 7, v1
    v_mul_u32_u24 v216, 3584, v3
    v_lshl_add_u32 v216, v47, 4, v216
    v_add_u32 v216, s8, v216
    v_add_u32 v219, 57344, v216
    v_mov_b32 v245, 0
    s_mov_b32 s56, 0xff00ff00
    s_mov_b32 s57, 0xff00ff00
    s_waitcnt vmcnt(0)
    v_mov_b32 v246, v22
    v_mov_b32 v247, v23
    s_cmp_lg_u32 s3, 0
    s_cbranch_scc1 TR_17
    s_lshl_b32 s6, s4, 11
    s_add_u32 s6, s6, 720960
    v_lshl_add_u32 v20, v2, 7, s6
    s_mov_b64 exec, 0xffff
    s_mov_b32 s66, 0
TP_18:
    s_add_u32 s66, s66, 1
    s_cmp_gt_u32 s66, 1048576
    s_cbranch_scc1 L_end
    s_cmp_eq_u32 s66, 300
    s_cselect_b32 s6, 0, 0
    v_add_u32 v20, s6, v20
    s_sleep 2
    global_load_dwordx4 v[220:223], v20, s[44:45] sc1
    s_waitcnt vmcnt(0)
    v_xor_b32 v21, v220, v248
    v_bitop3_b32 v21, v21, v221, v248 bitop3:0xf6
    v_bitop3_b32 v21, v21, v222, v248 bitop3:0xf6
    v_bitop3_b32 v21, v21, v223, v248 bitop3:0xf6
    v_and_b32 v21, 0xff, v21
    v_cmp_eq_u32 vcc, 0, v21
    s_nop 0
    s_bcnt1_i32_b64 s6, vcc
    s_cmp_lt_u32 s6, 4
    s_cbranch_scc1 TP_18
    s_mov_b64 exec, -1
TR_17:
    s_barrier
    global_load_lds_dwordx4 v8, s[10:11] offset:0 nt
    v_add_u32 v15, 113664, v8
    global_load_lds_dwordx4 v15, s[10:11] offset:1024 nt
    v_add_u32 v15, 12288, v8
    global_load_lds_dwordx4 v15, s[10:11] offset:2048 nt
    v_add_u32 v15, 125952, v8
    global_load_lds_dwordx4 v15, s[10:11] offset:3072 nt
    s_add_u32 m0, m0, 0x1000
    v_add_u32 v15, 28672, v8
    global_load_lds_dwordx4 v15, s[10:11] offset:0 nt
    v_add_u32 v15, 142336, v8
    global_load_lds_dwordx4 v15, s[10:11] offset:1024 nt
    v_add_u32 v15, 40960, v8
    global_load_lds_dwordx4 v15, s[10:11] offset:2048 nt
    v_add_u32 v15, 154624, v8
    global_load_lds_dwordx4 v15, s[10:11] offset:3072 nt
    s_barrier
    global_load_dwordx4 v[196:199], v41, s[44:45] offset:-2048 sc1
    global_load_dwordx4 v[48:51], v41, s[44:45] sc1
    global_load_dwordx4 v[200:203], v41, s[44:45] offset:2048 sc1
    s_mov_b32 m0, s14
    s_nop 0
    global_load_lds_dwordx4 v7, s[12:13] offset:0 nt
    v_add_u32 v15, 31744, v7
    global_load_lds_dwordx4 v15, s[12:13] offset:1024 nt
    v_add_u32 v15, 2048, v7
    global_load_lds_dwordx4 v15, s[12:13] offset:2048 nt
    v_add_u32 v15, 33792, v7
    global_load_lds_dwordx4 v15, s[12:13] offset:3072 nt
    s_add_u32 m0, m0, 0x1000
    v_add_u32 v15, 8192, v7
    global_load_lds_dwordx4 v15, s[12:13] offset:0 nt
    v_add_u32 v15, 39936, v7
    global_load_lds_dwordx4 v15, s[12:13] offset:1024 nt
    v_add_u32 v15, 10240, v7
    global_load_lds_dwordx4 v15, s[12:13] offset:2048 nt
    v_add_u32 v15, 41984, v7
    global_load_lds_dwordx4 v15, s[12:13] offset:3072 nt
    v_mov_b32 v22, v246
    v_mov_b32 v23, v247
    s_mov_b32 s66, 0
    s_waitcnt vmcnt(8)
Pc_21:
    v_xor_b32 v14, v196, v249
    v_bitop3_b32 v14, v14, v197, v249 bitop3:0xf6
    v_bitop3_b32 v14, v14, v198, v249 bitop3:0xf6
    v_bitop3_b32 v14, v14, v199, v249 bitop3:0xf6
    v_bitop3_b32 v14, v14, v48, v249 bitop3:0xf6
    v_bitop3_b32 v14, v14, v49, v249 bitop3:0xf6
    v_bitop3_b32 v14, v14, v50, v249 bitop3:0xf6
    v_bitop3_b32 v14, v14, v51, v249 bitop3:0xf6
    v_bitop3_b32 v14, v14, v200, v249 bitop3:0xf6
    v_bitop3_b32 v14, v14, v201, v249 bitop3:0xf6
    v_bitop3_b32 v14, v14, v202, v249 bitop3:0xf6
    v_bitop3_b32 v14, v14, v203, v249 bitop3:0xf6
    v_and_b32 v15, 0xffff, v14
    v_cmp_ne_u32 vcc, 0, v15
    s_cbranch_vccnz P_19
    v_and_b32 v196, s62, v196
    v_and_b32 v197, s62, v197
    v_and_b32 v198, s62, v198
    v_and_b32 v199, s62, v199
    v_and_b32 v200, s62, v200
    v_and_b32 v201, s62, v201
    v_and_b32 v202, s62, v202
    v_and_b32 v203, s62, v203
    v_add_f32 v200, 1.0, v200
    v_add_f32 v201, 1.0, v201
    v_add_f32 v202, 1.0, v202
    v_add_f32 v203, 1.0, v203
    v_cvt_pk_bf16_f32 v52, v200, v201
    v_lshlrev_b32 v200, 16, v52
    v_and_b32 v201, s62, v52
    v_cvt_pk_bf16_f32 v53, v202, v203
    v_lshlrev_b32 v202, 16, v53
    v_and_b32 v203, s62, v53
    v_lshlrev_b32 v192, 16, v16
    v_and_b32 v193, s62, v16
    v_lshlrev_b32 v194, 16, v17
    v_and_b32 v195, s62, v17
    v_lshlrev_b32 v20, 16, v22
    v_and_b32 v21, s62, v22
    v_lshlrev_b32 v22, 16, v23
    v_med3_f32 v244, v20, v21, v22
    v_perm_b32 v54, v49, v48, s60
    v_perm_b32 v55, v51, v50, s60
    v_cndmask_b32 v52, v52, v54, s[56:57]
    v_cndmask_b32 v53, v53, v55, s[56:57]
    s_nop 0
    v_mov_b32_dpp v96, v52 quad_perm:[0,0,0,0] row_mask:0xf bank_mask:0xf
    v_mov_b32_dpp v97, v53 quad_perm:[0,0,0,0] row_mask:0xf bank_mask:0xf
    v_mov_b32_dpp v98, v52 quad_perm:[1,1,1,1] row_mask:0xf bank_mask:0xf
    v_mov_b32_dpp v99, v53 quad_perm:[1,1,1,1] row_mask:0xf bank_mask:0xf
    v_mov_b32_dpp v100, v52 quad_perm:[2,2,2,2] row_mask:0xf bank_mask:0xf
    v_mov_b32_dpp v101, v53 quad_perm:[2,2,2,2] row_mask:0xf bank_mask:0xf
    v_mov_b32_dpp v102, v52 quad_perm:[3,3,3,3] row_mask:0xf bank_mask:0xf
    v_mov_b32_dpp v103, v53 quad_perm:[3,3,3,3] row_mask:0xf bank_mask:0xf
    v_sub_f32 v192, v192, v244
    v_sub_f32 v193, v193, v244
    v_sub_f32 v194, v194, v244
    v_sub_f32 v195, v195, v244
    v_pk_mul_f32 v[204:205], v[192:193], v[200:201]
    v_pk_mul_f32 v[206:207], v[194:195], v[202:203]
    v_pk_mul_f32 v[200:201], v[200:201], v[196:197]
    v_pk_mul_f32 v[202:203], v[202:203], v[198:199]
    s_waitcnt vmcnt(8)
    ds_read_b64_tr_b16 v[128:129], v26 offset:8192
    ds_read_b64_tr_b16 v[130:131], v26 offset:10240
    ds_read_b64_tr_b16 v[132:133], v27 offset:8192
    ds_read_b64_tr_b16 v[134:135], v27 offset:10240
    ds_read_b64_tr_b16 v[136:137], v28 offset:8192
    ds_read_b64_tr_b16 v[138:139], v28 offset:10240
    ds_read_b64_tr_b16 v[140:141], v29 offset:8192
    ds_read_b64_tr_b16 v[142:143], v29 offset:10240
    ds_read_b64_tr_b16 v[144:145], v26 offset:12288
    ds_read_b64_tr_b16 v[146:147], v26 offset:14336
    ds_read_b64_tr_b16 v[148:149], v27 offset:12288
    ds_read_b64_tr_b16 v[150:151], v27 offset:14336
    ds_read_b64_tr_b16 v[152:153], v28 offset:12288
    ds_read_b64_tr_b16 v[154:155], v28 offset:14336
    ds_read_b64_tr_b16 v[156:157], v29 offset:12288
    ds_read_b64_tr_b16 v[158:159], v29 offset:14336
    s_waitcnt lgkmcnt(0)
    v_mfma_f32_16x16x32_bf16 v[104:107], v[128:131], v[96:99], 0
    v_mfma_f32_16x16x32_bf16 v[108:111], v[132:135], v[96:99], 0
    v_mfma_f32_16x16x32_bf16 v[112:115], v[136:139], v[96:99], 0
    v_mfma_f32_16x16x32_bf16 v[116:119], v[140:143], v[96:99], 0
    v_mfma_f32_16x16x32_bf16 v[104:107], v[144:147], v[100:103], v[104:107]
    v_mfma_f32_16x16x32_bf16 v[108:111], v[148:151], v[100:103], v[108:111]
    v_mfma_f32_16x16x32_bf16 v[112:115], v[152:155], v[100:103], v[112:115]
    v_mfma_f32_16x16x32_bf16 v[116:119], v[156:159], v[100:103], v[116:119]
    s_nop 5
    v_cndmask_b32 v104, v104, v108, s[50:51]
    v_cndmask_b32 v105, v105, v109, s[50:51]
    v_cndmask_b32 v106, v106, v110, s[50:51]
    v_cndmask_b32 v107, v107, v111, s[50:51]
    v_cndmask_b32 v104, v104, v112, s[52:53]
    v_cndmask_b32 v105, v105, v113, s[52:53]
    v_cndmask_b32 v106, v106, v114, s[52:53]
    v_cndmask_b32 v107, v107, v115, s[52:53]
    v_cndmask_b32 v104, v104, v116, s[54:55]
    v_cndmask_b32 v105, v105, v117, s[54:55]
    v_cndmask_b32 v106, v106, v118, s[54:55]
    v_cndmask_b32 v107, v107, v119, s[54:55]
    ds_write_b128 v30, v[104:107]
    s_waitcnt lgkmcnt(0)
    s_barrier
    ds_read2_b64 v[64:67], v213 offset0:0 offset1:16
    ds_read_b64 v[68:69], v213 offset:1280
    ds_read_b64 v[70:71], v213 offset:1408
    ds_read_b64 v[72:73], v213 offset:2560
    ds_read_b64 v[74:75], v213 offset:2688
    ds_read_b64 v[76:77], v213 offset:3840
    ds_read_b64 v[78:79], v213 offset:3968
    ds_read_b64 v[80:81], v213 offset:5120
    ds_read_b64 v[82:83], v213 offset:5248
    ds_read_b64 v[84:85], v213 offset:6400
    ds_read_b64 v[86:87], v213 offset:6528
    ds_read_b64 v[88:89], v213 offset:7680
    ds_read_b64 v[90:91], v213 offset:7808
    ds_read_b64 v[92:93], v213 offset:8960
    ds_read_b64 v[94:95], v213 offset:9088
    v_lshlrev_b32 v210, 16, v18
    v_and_b32 v211, s62, v18
    s_waitcnt lgkmcnt(0)
    v_pk_add_f32 v[208:209], v[64:65], v[68:69]
    v_pk_add_f32 v[210:211], v[210:211], v[66:67]
    v_pk_add_f32 v[210:211], v[210:211], v[70:71]
    v_pk_add_f32 v[208:209], v[208:209], v[72:73]
    v_pk_add_f32 v[210:211], v[210:211], v[74:75]
    v_pk_add_f32 v[208:209], v[208:209], v[76:77]
    v_pk_add_f32 v[210:211], v[210:211], v[78:79]
    v_pk_add_f32 v[208:209], v[208:209], v[80:81]
    v_pk_add_f32 v[210:211], v[210:211], v[82:83]
    v_pk_add_f32 v[208:209], v[208:209], v[84:85]
    v_pk_add_f32 v[210:211], v[210:211], v[86:87]
    v_pk_add_f32 v[208:209], v[208:209], v[88:89]
    v_pk_add_f32 v[210:211], v[210:211], v[90:91]
    v_pk_add_f32 v[208:209], v[208:209], v[92:93]
    v_pk_add_f32 v[210:211], v[210:211], v[94:95]
    s_waitcnt vmcnt(0)
    s_barrier
    s_cmp_ge_u32 s3, 4
    s_cbranch_scc1 L_F_rdy
    ds_read_b64_tr_b16 v[160:161], v26 offset:0
    ds_read_b64_tr_b16 v[162:163], v26 offset:2048
    ds_read_b64_tr_b16 v[164:165], v27 offset:0
    ds_read_b64_tr_b16 v[166:167], v27 offset:2048
    ds_read_b64_tr_b16 v[168:169], v28 offset:0
    ds_read_b64_tr_b16 v[170:171], v28 offset:2048
    ds_read_b64_tr_b16 v[172:173], v29 offset:0
    ds_read_b64_tr_b16 v[174:175], v29 offset:2048
    ds_read_b64_tr_b16 v[176:177], v26 offset:4096
    ds_read_b64_tr_b16 v[178:179], v26 offset:6144
    ds_read_b64_tr_b16 v[180:181], v27 offset:4096
    ds_read_b64_tr_b16 v[182:183], v27 offset:6144
    ds_read_b64_tr_b16 v[184:185], v28 offset:4096
    ds_read_b64_tr_b16 v[186:187], v28 offset:6144
    ds_read_b64_tr_b16 v[188:189], v29 offset:4096
    ds_read_b64_tr_b16 v[190:191], v29 offset:6144
    v_xor_b32 v26, 0x10000, v26
    v_xor_b32 v27, 0x10000, v27
    v_xor_b32 v28, 0x10000, v28
    v_xor_b32 v29, 0x10000, v29
    ds_read_b64_tr_b16 v[64:65], v26 offset:0
    ds_read_b64_tr_b16 v[66:67], v26 offset:2048
    ds_read_b64_tr_b16 v[68:69], v27 offset:0
    ds_read_b64_tr_b16 v[70:71], v27 offset:2048
    ds_read_b64_tr_b16 v[72:73], v28 offset:0
    ds_read_b64_tr_b16 v[74:75], v28 offset:2048
    ds_read_b64_tr_b16 v[76:77], v29 offset:0
    ds_read_b64_tr_b16 v[78:79], v29 offset:2048
    ds_read_b64_tr_b16 v[80:81], v26 offset:4096
    ds_read_b64_tr_b16 v[82:83], v26 offset:6144
    ds_read_b64_tr_b16 v[84:85], v27 offset:4096
    ds_read_b64_tr_b16 v[86:87], v27 offset:6144
    ds_read_b64_tr_b16 v[88:89], v28 offset:4096
    ds_read_b64_tr_b16 v[90:91], v28 offset:6144
    ds_read_b64_tr_b16 v[92:93], v29 offset:4096
    ds_read_b64_tr_b16 v[94:95], v29 offset:6144
L_F_rdy:
    s_setprio 2
    global_load_dwordx4 v[224:227], v212, s[44:45] offset:0 sc1
    global_load_dwordx4 v[228:231], v212, s[44:45] offset:512 sc1
    global_load_dwordx4 v[232:235], v212, s[44:45] offset:1024 sc1
    global_load_dwordx4 v[236:239], v212, s[44:45] offset:1536 sc1
    s_mov_b32 s66, 0
    s_waitcnt vmcnt(0)
    s_branch Gc_24
G_23:
    s_wqm_b64 exec, s[6:7]
    global_load_dwordx4 v[224:227], v212, s[44:45] offset:0 sc1
    s_wqm_b64 exec, s[8:9]
    global_load_dwordx4 v[228:231], v212, s[44:45] offset:512 sc1
    s_wqm_b64 exec, s[10:11]
    global_load_dwordx4 v[232:235], v212, s[44:45] offset:1024 sc1
    s_wqm_b64 exec, s[12:13]
    global_load_dwordx4 v[236:239], v212, s[44:45] offset:1536 sc1
    s_mov_b64 exec, -1
    s_add_u32 s66, s66, 1
    s_cmp_gt_u32 s66, 1048576
    s_cbranch_scc1 L_end
    s_waitcnt vmcnt(0)
Gc_24:
    v_cmp_ne_u32_sdwa s[6:7], v227, v248 src0_sel:BYTE_0 src1_sel:BYTE_0
    v_cmp_ne_u32_sdwa s[8:9], v231, v248 src0_sel:BYTE_0 src1_sel:BYTE_0
    v_cmp_ne_u32_sdwa s[10:11], v235, v248 src0_sel:BYTE_0 src1_sel:BYTE_0
    v_cmp_ne_u32_sdwa s[12:13], v239, v248 src0_sel:BYTE_0 src1_sel:BYTE_0
    s_or_b64 vcc, s[6:7], s[8:9]
    s_or_b64 vcc, vcc, s[10:11]
    s_or_b64 vcc, vcc, s[12:13]
    s_cbranch_scc1 G_23
    v_and_b32 v227, s63, v227
    v_and_b32 v231, s63, v231
    v_and_b32 v235, s63, v235
    v_and_b32 v239, s63, v239
    v_pk_add_f32 v[40:41], v[224:225], v[228:229]
    v_pk_add_f32 v[42:43], v[226:227], v[230:231]
    v_pk_add_f32 v[48:49], v[232:233], v[236:237]
    v_pk_add_f32 v[50:51], v[234:235], v[238:239]
    v_pk_add_f32 v[40:41], v[40:41], v[48:49]
    v_pk_add_f32 v[42:43], v[42:43], v[50:51]
    s_nop 0
    v_add_f32_dpp v40, v40, v40 row_ror:8 row_mask:0xf bank_mask:0xf
    v_add_f32_dpp v41, v41, v41 row_ror:8 row_mask:0xf bank_mask:0xf
    v_add_f32_dpp v42, v42, v42 row_ror:8 row_mask:0xf bank_mask:0xf
    v_add_f32_dpp v43, v43, v43 row_ror:8 row_mask:0xf bank_mask:0xf
    v_pk_fma_f32 v[46:47], v[40:41], v[200:201], v[204:205]
    v_pk_fma_f32 v[48:49], v[42:43], v[202:203], v[206:207]
    v_cvt_pk_bf16_f32 v46, v46, v47
    v_cvt_pk_bf16_f32 v47, v48, v49
    v_pk_fma_f32 v[40:41], v[40:41], v[196:197], v[192:193]
    v_pk_fma_f32 v[42:43], v[42:43], v[198:199], v[194:195]
    v_mov_b32_dpp v96, v46 quad_perm:[0,0,0,0] row_mask:0xf bank_mask:0xf
    v_mov_b32_dpp v97, v47 quad_perm:[0,0,0,0] row_mask:0xf bank_mask:0xf
    v_mov_b32_dpp v98, v46 quad_perm:[1,1,1,1] row_mask:0xf bank_mask:0xf
    v_mov_b32_dpp v99, v47 quad_perm:[1,1,1,1] row_mask:0xf bank_mask:0xf
    v_mov_b32_dpp v100, v46 quad_perm:[2,2,2,2] row_mask:0xf bank_mask:0xf
    v_mov_b32_dpp v101, v47 quad_perm:[2,2,2,2] row_mask:0xf bank_mask:0xf
    v_mov_b32_dpp v102, v46 quad_perm:[3,3,3,3] row_mask:0xf bank_mask:0xf
    v_mov_b32_dpp v103, v47 quad_perm:[3,3,3,3] row_mask:0xf bank_mask:0xf
    v_mfma_f32_16x16x32_bf16 v[104:107], v[128:131], v[96:99], 0
    v_mfma_f32_16x16x32_bf16 v[108:111], v[132:135], v[96:99], 0
    v_mfma_f32_16x16x32_bf16 v[112:115], v[136:139], v[96:99], 0
    v_mfma_f32_16x16x32_bf16 v[116:119], v[140:143], v[96:99], 0
    v_pk_add_f32 v[50:51], v[40:41], v[42:43]
    v_pk_mul_f32 v[52:53], v[40:41], v[40:41]
    v_pk_fma_f32 v[52:53], v[42:43], v[42:43], v[52:53]
    v_add_f32 v50, v50, v51
    v_mfma_f32_16x16x32_bf16 v[104:107], v[144:147], v[100:103], v[104:107]
    v_add_f32 v52, v52, v53
    v_add_f32_dpp v50, v50, v50 quad_perm:[1,0,3,2] row_mask:0xf bank_mask:0xf
    v_mfma_f32_16x16x32_bf16 v[108:111], v[148:151], v[100:103], v[108:111]
    v_add_f32_dpp v52, v52, v52 quad_perm:[1,0,3,2] row_mask:0xf bank_mask:0xf
    v_add_f32_dpp v50, v50, v50 quad_perm:[2,3,0,1] row_mask:0xf bank_mask:0xf
    v_mfma_f32_16x16x32_bf16 v[112:115], v[152:155], v[100:103], v[112:115]
    v_add_f32_dpp v52, v52, v52 quad_perm:[2,3,0,1] row_mask:0xf bank_mask:0xf
    v_mfma_f32_16x16x32_bf16 v[116:119], v[156:159], v[100:103], v[116:119]
    s_nop 0
    v_permlane16_swap_b32 v50, v52
    v_add_f32 v50, v50, v52
    v_mov_b32 v52, v50
    v_cndmask_b32 v104, v104, v108, s[50:51]
    v_cndmask_b32 v105, v105, v109, s[50:51]
    v_cndmask_b32 v106, v106, v110, s[50:51]
    v_cndmask_b32 v107, v107, v111, s[50:51]
    v_permlane32_swap_b32 v50, v52
    v_add_f32 v50, v50, v52
    ds_write_b32 v217, v50
    v_cndmask_b32 v104, v104, v112, s[52:53]
    v_cndmask_b32 v105, v105, v113, s[52:53]
    v_cndmask_b32 v106, v106, v114, s[52:53]
    v_cndmask_b32 v107, v107, v115, s[52:53]
    v_cndmask_b32 v104, v104, v116, s[54:55]
    v_cndmask_b32 v105, v105, v117, s[54:55]
    v_cndmask_b32 v106, v106, v118, s[54:55]
    v_cndmask_b32 v107, v107, v119, s[54:55]
    s_cmp_ge_u32 s3, 4
    ds_write_b128 v30, v[104:107]
    s_waitcnt lgkmcnt(0)
    s_barrier
    s_cbranch_scc1 L_end
    ds_read_b64 v[34:35], v215
    ds_read_b64 v[40:41], v213 offset:0
    ds_read_b64 v[42:43], v213 offset:1280
    ds_read_b64 v[44:45], v213 offset:2560
    ds_read_b64 v[46:47], v213 offset:3840
    ds_read_b64 v[48:49], v213 offset:5120
    ds_read_b64 v[50:51], v213 offset:6400
    ds_read_b64 v[52:53], v213 offset:7680
    ds_read_b64 v[54:55], v213 offset:8960
    s_waitcnt lgkmcnt(8)
    v_add_f32_dpp v34, v34, v34 quad_perm:[1,0,3,2] row_mask:0xf bank_mask:0xf
    v_add_f32_dpp v35, v35, v35 quad_perm:[1,0,3,2] row_mask:0xf bank_mask:0xf
    s_waitcnt lgkmcnt(6)
    v_pk_add_f32 v[40:41], v[40:41], v[42:43]
    v_add_f32_dpp v34, v34, v34 quad_perm:[2,3,0,1] row_mask:0xf bank_mask:0xf
    v_add_f32_dpp v35, v35, v35 quad_perm:[2,3,0,1] row_mask:0xf bank_mask:0xf
    s_waitcnt lgkmcnt(4)
    v_pk_add_f32 v[44:45], v[44:45], v[46:47]
    v_add_f32_dpp v34, v34, v34 row_ror:8 row_mask:0xf bank_mask:0xf
    v_add_f32_dpp v35, v35, v35 row_ror:8 row_mask:0xf bank_mask:0xf
    v_pk_add_f32 v[40:41], v[40:41], v[44:45]
    v_mul_f32 v34, 0x3b000000, v34
    v_mul_f32 v35, 0x3b000000, v35
    v_fma_f32 v38, -v34, v34, v35
    v_add_f32 v36, v244, v34
    v_max_f32 v38, 0, v38
    v_cvt_pk_bf16_f32 v38, v36, v38
    v_lshlrev_b32 v36, 16, v38
    v_and_b32 v38, s62, v38
    v_add_f32 v38, 0x3727c5ac, v38
    v_cvt_pk_bf16_f32 v38, v38, v38
    v_and_b32 v38, s62, v38
    v_sqrt_f32 v38, v38
    v_sub_f32 v36, v244, v36
    s_waitcnt lgkmcnt(0)
    v_pk_add_f32 v[48:49], v[48:49], v[50:51]
    v_pk_add_f32 v[52:53], v[52:53], v[54:55]
    v_cvt_pk_bf16_f32 v38, v38, v38
    v_and_b32 v38, s62, v38
    v_rcp_f32 v38, v38
    v_pk_add_f32 v[40:41], v[40:41], v[48:49]
    v_pk_add_f32 v[40:41], v[40:41], v[52:53]
    v_pk_fma_f32 v[40:41], v[208:209], v[36:37], v[40:41] op_sel_hi:[1,0,1]
    v_pk_fma_f32 v[40:41], v[40:41], v[38:39], v[210:211] op_sel_hi:[1,0,1]
    v_max_f32 v40, 0, v40
    v_max_f32 v41, 0, v41
    v_pk_mul_f32 v[40:41], v[40:41], v[40:41]
    v_cvt_pk_bf16_f32 v42, v40, v41
    s_nop 1
    v_mov_b32_dpp v96, v42 quad_perm:[0,0,0,0] row_mask:0xf bank_mask:0xf
    v_mov_b32_dpp v97, v42 quad_perm:[1,1,1,1] row_mask:0xf bank_mask:0xf
    v_mov_b32_dpp v98, v42 quad_perm:[2,2,2,2] row_mask:0xf bank_mask:0xf
    v_mov_b32_dpp v99, v42 quad_perm:[3,3,3,3] row_mask:0xf bank_mask:0xf
    v_mov_b32_dpp v100, v96 row_ror:8 row_mask:0xf bank_mask:0xf
    v_mov_b32_dpp v101, v97 row_ror:8 row_mask:0xf bank_mask:0xf
    v_mov_b32_dpp v102, v98 row_ror:8 row_mask:0xf bank_mask:0xf
    v_mov_b32_dpp v103, v99 row_ror:8 row_mask:0xf bank_mask:0xf
    v_mfma_f32_16x16x32_bf16 v[104:107], v[160:163], v[96:99], 0
    v_mfma_f32_16x16x32_bf16 v[108:111], v[164:167], v[96:99], 0
    v_mfma_f32_16x16x32_bf16 v[112:115], v[168:171], v[96:99], 0
    v_mfma_f32_16x16x32_bf16 v[116:119], v[172:175], v[96:99], 0
    v_mfma_f32_16x16x32_bf16 v[104:107], v[176:179], v[100:103], v[104:107]
    v_mfma_f32_16x16x32_bf16 v[108:111], v[180:183], v[100:103], v[108:111]
    v_mfma_f32_16x16x32_bf16 v[112:115], v[184:187], v[100:103], v[112:115]
    v_mfma_f32_16x16x32_bf16 v[116:119], v[188:191], v[100:103], v[116:119]
    v_mfma_f32_16x16x32_bf16 v[40:43], v[64:67], v[96:99], 0
    v_mfma_f32_16x16x32_bf16 v[44:47], v[68:71], v[96:99], 0
    v_mfma_f32_16x16x32_bf16 v[48:51], v[72:75], v[96:99], 0
    v_mfma_f32_16x16x32_bf16 v[52:55], v[76:79], v[96:99], 0
    v_mfma_f32_16x16x32_bf16 v[40:43], v[80:83], v[100:103], v[40:43]
    s_nop 0
    v_cndmask_b32 v104, v104, v108, s[50:51]
    v_cndmask_b32 v105, v105, v109, s[50:51]
    v_cndmask_b32 v106, v106, v110, s[50:51]
    v_cndmask_b32 v107, v107, v111, s[50:51]
    v_mfma_f32_16x16x32_bf16 v[44:47], v[84:87], v[100:103], v[44:47]
    v_cndmask_b32 v104, v104, v112, s[52:53]
    v_cndmask_b32 v105, v105, v113, s[52:53]
    v_cndmask_b32 v106, v106, v114, s[52:53]
    v_cndmask_b32 v107, v107, v115, s[52:53]
    v_mfma_f32_16x16x32_bf16 v[48:51], v[88:91], v[100:103], v[48:51]
    v_cndmask_b32 v104, v104, v116, s[54:55]
    v_cndmask_b32 v105, v105, v117, s[54:55]
    v_cndmask_b32 v106, v106, v118, s[54:55]
    v_cndmask_b32 v107, v107, v119, s[54:55]
    v_mfma_f32_16x16x32_bf16 v[52:55], v[92:95], v[100:103], v[52:55]
    v_and_or_b32 v107, v107, s63, v248
    v_and_or_b32 v105, v105, s63, v248
    s_mov_b64 exec, s[58:59]
    global_store_dwordx4 v216, v[104:107], s[44:45] sc1
    v_cndmask_b32 v40, v40, v44, s[50:51]
    v_cndmask_b32 v41, v41, v45, s[50:51]
    v_cndmask_b32 v42, v42, v46, s[50:51]
    v_cndmask_b32 v43, v43, v47, s[50:51]
    v_cndmask_b32 v40, v40, v48, s[52:53]
    v_cndmask_b32 v41, v41, v49, s[52:53]
    v_cndmask_b32 v42, v42, v50, s[52:53]
    v_cndmask_b32 v43, v43, v51, s[52:53]
    v_cndmask_b32 v40, v40, v52, s[54:55]
    v_cndmask_b32 v41, v41, v53, s[54:55]
    v_cndmask_b32 v42, v42, v54, s[54:55]
    v_cndmask_b32 v43, v43, v55, s[54:55]
    v_and_or_b32 v43, v43, s63, v248
    v_and_or_b32 v41, v41, s63, v248
    global_store_dwordx4 v219, v[40:43], s[44:45] sc1
    s_endpgm
L_F_spare:
    s_cmp_lg_u32 s2, 248
    s_cbranch_scc1 L_end
    s_cmp_lg_u32 s3, 0
    s_cbranch_scc1 L_end
    v_lshlrev_b32 v20, 8, v1
    v_add_u32 v20, 1048576, v20
    v_and_b32 v21, 31, v1
    v_lshlrev_b32 v21, 8, v21
    v_add_u32 v21, 16384, v21
    s_mov_b32 s66, 0
P_25:
    s_add_u32 s66, s66, 1
    s_cmp_gt_u32 s66, 1048576
    s_cbranch_scc1 L_end
Pq_26:
    s_sleep 8
    global_load_dword v40, v20, s[44:45] offset:12 sc1
    global_load_dword v41, v20, s[44:45] offset:28 sc1
    global_load_dword v42, v20, s[44:45] offset:44 sc1
    global_load_dword v43, v20, s[44:45] offset:60 sc1
    global_load_dwordx4 v[44:47], v21, s[44:45] sc1
    s_waitcnt vmcnt(0)
    v_xor_b32 v14, v40, v248
    v_bitop3_b32 v14, v14, v41, v248 bitop3:0xf6
    v_bitop3_b32 v14, v14, v42, v248 bitop3:0xf6
    v_bitop3_b32 v14, v14, v43, v248 bitop3:0xf6
    v_bitop3_b32 v14, v14, v44, v248 bitop3:0xf6
    v_bitop3_b32 v14, v14, v45, v248 bitop3:0xf6
    v_bitop3_b32 v14, v14, v46, v248 bitop3:0xf6
    v_bitop3_b32 v14, v14, v47, v248 bitop3:0xf6
    v_and_b32 v15, 0xff, v14
    v_cmp_ne_u32 vcc, 0, v15
    s_cbranch_vccnz P_25
    s_add_u32 s6, s48, 1
    v_mov_b32 v20, s6
    v_mov_b32 v21, 0
    s_mov_b64 exec, 1
    global_store_dword v21, v20, s[44:45] sc1
    s_endpgm
    .p2align 6
L_W:
    v_lshrrev_b32 v1, 6, v0
    s_and_b32 s4, s2, 7
    s_lshr_b32 s5, s2, 3
    v_readfirstlane_b32 s3, v1
    v_and_b32 v1, 63, v0
    v_and_b32 v2, 15, v0
    v_lshrrev_b32 v3, 4, v1
    s_lshl_b32 s14, s3, 14
    s_mov_b32 m0, s14
    s_sub_u32 s5, s5, 16
    v_and_b32 v6, 1, v3
    v_xor_b32 v6, v6, v1
    v_and_b32 v6, 7, v6
    v_lshlrev_b32 v6, 4, v6
    v_bfe_u32 v7, v1, 3, 2
    v_lshrrev_b32 v9, 5, v1
    v_lshl_add_u32 v4, v9, 4, v7
    v_lshrrev_b32 v11, 2, v2
    v_and_b32 v12, 3, v1
    v_lshlrev_b32 v10, 2, v12
    v_lshl_add_u32 v10, v3, 4, v10
    v_lshlrev_b32 v13, 10, v11
    v_lshl_add_u32 v13, v10, 1, v13
    s_lshl_b32 s6, s3, 7
    v_add_u32 v13, s6, v13
    v_lshl_add_u32 v8, v4, 13, v6
    s_lshl_b32 s9, s3, 19
    s_lshl_b32 s6, s4, 10
    s_add_u32 s9, s9, s6
    s_lshl_b32 s6, s5, 7
    s_add_u32 s9, s9, s6
    s_and_b32 s6, s3, 3
    s_lshl_b32 s6, s6, 10
    v_lshl_add_u32 v14, v1, 4, s6
    s_waitcnt lgkmcnt(0)
    s_load_dword s48, s[44:45], 0
    s_add_u32 s12, s22, s9
    s_addc_u32 s13, s23, 0
    s_cmp_ge_u32 s3, 4
    s_cbranch_scc1 L_W_pfq
    s_mul_i32 s6, s5, 4
    s_add_u32 s6, s6, s3
    s_lshl_b32 s6, s6, 16
    s_lshl_b32 s7, s4, 10
    s_add_u32 s6, s6, s7
    s_add_u32 s6, s6, 2097536
    v_lshrrev_b32 v24, 3, v1
    v_lshlrev_b32 v24, 13, v24
    v_and_b32 v25, 7, v1
    v_lshl_add_u32 v24, v25, 4, v24
    v_add_u32 v24, s6, v24
    global_load_dwordx4 v[240:243], v24, s[22:23]
L_W_pfq:
    global_load_lds_dwordx4 v8, s[12:13] offset:0 nt
    v_add_u32 v15, 261120, v8
    global_load_lds_dwordx4 v15, s[12:13] offset:1024 nt
    v_add_u32 v15, 30720, v8
    global_load_lds_dwordx4 v15, s[12:13] offset:2048 nt
    v_add_u32 v15, 291840, v8
    global_load_lds_dwordx4 v15, s[12:13] offset:3072 nt
    global_load_dwordx4 v[20:23], v14, s[16:17]
    global_load_dwordx2 v[16:17], v13, s[16:17]
    s_add_u32 m0, m0, 0x1000
    v_add_u32 v15, 65536, v8
    global_load_lds_dwordx4 v15, s[12:13] offset:0 nt
    v_add_u32 v15, 326656, v8
    global_load_lds_dwordx4 v15, s[12:13] offset:1024 nt
    v_add_u32 v15, 96256, v8
    global_load_lds_dwordx4 v15, s[12:13] offset:2048 nt
    v_add_u32 v15, 357376, v8
    global_load_lds_dwordx4 v15, s[12:13] offset:3072 nt
    s_mov_b32 s60, 0x07060302
    s_mov_b32 s61, 0x05040100
    s_mov_b32 s62, 0xffff0000
    s_mov_b32 s63, 0xffffff00
    s_mov_b32 s64, 0x3fb8aa3b
    s_getreg_b32 s49, hwreg(HW_REG_XCC_ID, 0, 4)
    s_mov_b32 s50, 0x22222222
    s_mov_b32 s51, 0x22222222
    s_mov_b32 s52, 0x44444444
    s_mov_b32 s53, 0x44444444
    s_mov_b32 s54, 0x88888888
    s_mov_b32 s55, 0x88888888
    s_mov_b32 s58, 0x00ff00ff
    s_mov_b32 s59, 0x00ff00ff
    v_lshrrev_b32 v15, 2, v1
    v_lshl_add_u32 v18, v12, 5, s14
    v_lshl_add_u32 v26, v15, 7, v18
    v_bfe_u32 v19, v1, 3, 1
    v_lshl_add_u32 v26, v19, 4, v26
    v_xor_b32 v27, 8, v26
    v_xor_b32 v28, 16, v26
    v_xor_b32 v29, 24, v26
    s_mul_i32 s6, s3, 1280
    s_add_u32 s6, s6, 131072
    v_mul_u32_u24 v31, 320, v3
    v_lshl_add_u32 v30, v2, 4, v31
    v_add_u32 v30, s6, v30
    s_lshl_b32 s6, s3, 6
    s_add_u32 s6, s6, 131072
    v_lshl_add_u32 v31, v2, 2, v31
    v_add_u32 v31, s6, v31
    s_waitcnt vmcnt(4)
    v_lshlrev_b32 v40, 16, v20
    v_and_b32 v41, s62, v20
    v_lshlrev_b32 v42, 16, v21
    v_and_b32 v43, s62, v21
    v_lshlrev_b32 v44, 16, v22
    v_and_b32 v45, s62, v22
    v_lshlrev_b32 v46, 16, v23
    v_and_b32 v47, s62, v23
    v_readfirstlane_b32 s6, v40
    s_nop 1
    v_subrev_f32 v40, s6, v40
    v_subrev_f32 v41, s6, v41
    v_subrev_f32 v42, s6, v42
    v_subrev_f32 v43, s6, v43
    v_subrev_f32 v44, s6, v44
    v_subrev_f32 v45, s6, v45
    v_subrev_f32 v46, s6, v46
    v_subrev_f32 v47, s6, v47
    v_add_f32 v48, v40, v41
    v_mul_f32 v49, v40, v40
    v_fmac_f32 v49, v41, v41
    v_add_f32 v48, v48, v42
    v_fmac_f32 v49, v42, v42
    v_add_f32 v48, v48, v43
    v_fmac_f32 v49, v43, v43
    v_add_f32 v48, v48, v44
    v_fmac_f32 v49, v44, v44
    v_add_f32 v48, v48, v45
    v_fmac_f32 v49, v45, v45
    v_add_f32 v48, v48, v46
    v_fmac_f32 v49, v46, v46
    v_add_f32 v48, v48, v47
    v_fmac_f32 v49, v47, v47
    s_nop 0
    v_add_f32_dpp v48, v48, v48 quad_perm:[1,0,3,2] row_mask:0xf bank_mask:0xf
    v_add_f32_dpp v49, v49, v49 quad_perm:[1,0,3,2] row_mask:0xf bank_mask:0xf
    s_nop 0
    v_add_f32_dpp v48, v48, v48 quad_perm:[2,3,0,1] row_mask:0xf bank_mask:0xf
    v_add_f32_dpp v49, v49, v49 quad_perm:[2,3,0,1] row_mask:0xf bank_mask:0xf
    s_nop 0
    v_add_f32_dpp v48, v48, v48 row_ror:4 row_mask:0xf bank_mask:0xf
    v_add_f32_dpp v49, v49, v49 row_ror:4 row_mask:0xf bank_mask:0xf
    s_nop 0
    v_add_f32_dpp v48, v48, v48 row_ror:8 row_mask:0xf bank_mask:0xf
    v_add_f32_dpp v49, v49, v49 row_ror:8 row_mask:0xf bank_mask:0xf
    s_nop 1
    v_permlane16_swap_b32 v48, v49
    v_add_f32 v48, v48, v49
    v_mov_b32 v50, v48
    s_nop 1
    v_permlane32_swap_b32 v48, v50
    v_add_f32 v48, v48, v50
    s_nop 0
    v_readlane_b32 s7, v48, 0
    v_readlane_b32 s8, v48, 16
    v_mov_b32 v50, 0x3b000000
    v_mul_f32 v48, s7, v50
    v_mul_f32 v49, s8, v50
    v_fma_f32 v49, -v48, v48, v49
    v_add_f32 v48, s6, v48
    v_max_f32 v49, 0, v49
    v_cvt_pk_bf16_f32 v49, v48, v49
    v_lshlrev_b32 v48, 16, v49
    v_and_b32 v49, s62, v49
    v_add_f32 v49, 0x3727c5ac, v49
    v_cvt_pk_bf16_f32 v49, v49, v49
    v_and_b32 v49, s62, v49
    v_sqrt_f32 v49, v49
    s_nop 0
    v_cvt_pk_bf16_f32 v49, v49, v49
    v_and_b32 v49, s62, v49
    v_rcp_f32 v49, v49
    s_and_b32 s6, s3, 3
    s_lshl_b32 s6, s6, 3
    s_add_u32 s6, s6, 141824
    v_mov_b32 v50, s6
    ds_write_b64 v50, v[48:49]
    v_lshlrev_b32 v50, 3, v11
    v_add_u32 v50, 141824, v50
    s_waitcnt lgkmcnt(0)
    s_barrier
    ds_read_b64 v[48:49], v50
    s_add_u32 s46, s48, 1
    s_and_b32 s46, s46, 0xff
    s_lshl_b32 s47, s46, 8
    s_or_b32 s47, s47, s46
    s_lshl_b32 s67, s49, 8
    s_or_b32 s67, s67, s46
    v_mov_b32 v248, s46
    v_mov_b32 v249, s47
    v_mov_b32 v250, s67
    v_lshlrev_b32 v32, 16, v16
    v_and_b32 v33, s62, v16
    v_lshlrev_b32 v34, 16, v17
    v_and_b32 v35, s62, v17
    s_lshl_b32 s6, s3, 12
    s_add_u32 s6, s6, 131072
    v_lshl_add_u32 v13, v11, 8, s6
    v_lshl_add_u32 v13, v10, 2, v13
    s_lshl_b32 s6, s4, 13
    s_lshl_b32 s7, s5, 8
    s_add_u32 s6, s6, s7
    s_lshl_b32 s7, s3, 11
    s_add_u32 s6, s6, s7
    s_add_u32 s6, s6, 65536
    v_lshl_add_u32 v56, v1, 2, s6
    v_add_u32 v57, 524288, v56
    s_waitcnt lgkmcnt(0)
    v_sub_f32 v32, v32, v48
    v_sub_f32 v33, v33, v48
    v_sub_f32 v34, v34, v48
    v_sub_f32 v35, v35, v48
    v_cvt_pk_bf16_f32 v36, v32, v33
    v_lshlrev_b32 v32, 16, v36
    v_and_b32 v33, s62, v36
    v_cvt_pk_bf16_f32 v37, v34, v35
    v_lshlrev_b32 v34, 16, v37
    v_and_b32 v35, s62, v37
    v_mul_f32 v32, v32, v49
    v_mul_f32 v33, v33, v49
    v_mul_f32 v34, v34, v49
    v_mul_f32 v35, v35, v49
    v_cvt_pk_bf16_f32 v36, v32, v33
    v_lshlrev_b32 v32, 16, v36
    v_and_b32 v33, s62, v36
    v_cvt_pk_bf16_f32 v37, v34, v35
    v_lshlrev_b32 v34, 16, v37
    v_and_b32 v35, s62, v37
    s_waitcnt vmcnt(0)
    ds_read_b64_tr_b16 v[128:129], v26 offset:0
    ds_read_b64_tr_b16 v[130:131], v26 offset:2048
    ds_read_b64_tr_b16 v[132:133], v27 offset:0
    ds_read_b64_tr_b16 v[134:135], v27 offset:2048
    ds_read_b64_tr_b16 v[136:137], v28 offset:0
    ds_read_b64_tr_b16 v[138:139], v28 offset:2048
    ds_read_b64_tr_b16 v[140:141], v29 offset:0
    ds_read_b64_tr_b16 v[142:143], v29 offset:2048
    ds_read_b64_tr_b16 v[144:145], v26 offset:4096
    ds_read_b64_tr_b16 v[146:147], v26 offset:6144
    ds_read_b64_tr_b16 v[148:149], v27 offset:4096
    ds_read_b64_tr_b16 v[150:151], v27 offset:6144
    ds_read_b64_tr_b16 v[152:153], v28 offset:4096
    ds_read_b64_tr_b16 v[154:155], v28 offset:6144
    ds_read_b64_tr_b16 v[156:157], v29 offset:4096
    ds_read_b64_tr_b16 v[158:159], v29 offset:6144
    s_mov_b32 s66, 0
P_29:
    s_add_u32 s66, s66, 1
    s_cmp_gt_u32 s66, 1048576
    s_cbranch_scc1 L_end
Pq_30:
    global_load_dwordx4 v[40:43], v13, s[44:45] offset:0 sc1
    global_load_dwordx4 v[44:47], v13, s[44:45] offset:1024 sc1
    global_load_dwordx4 v[48:51], v13, s[44:45] offset:2048 sc1
    global_load_dwordx4 v[52:55], v13, s[44:45] offset:3072 sc1
    s_waitcnt vmcnt(0)
    v_xor_b32 v14, v40, v248
    v_bitop3_b32 v14, v14, v41, v248 bitop3:0xf6
    v_bitop3_b32 v14, v14, v42, v248 bitop3:0xf6
    v_bitop3_b32 v14, v14, v43, v248 bitop3:0xf6
    v_bitop3_b32 v14, v14, v44, v248 bitop3:0xf6
    v_bitop3_b32 v14, v14, v45, v248 bitop3:0xf6
    v_bitop3_b32 v14, v14, v46, v248 bitop3:0xf6
    v_bitop3_b32 v14, v14, v47, v248 bitop3:0xf6
    v_bitop3_b32 v14, v14, v48, v248 bitop3:0xf6
    v_bitop3_b32 v14, v14, v49, v248 bitop3:0xf6
    v_bitop3_b32 v14, v14, v50, v248 bitop3:0xf6
    v_bitop3_b32 v14, v14, v51, v248 bitop3:0xf6
    v_bitop3_b32 v14, v14, v52, v248 bitop3:0xf6
    v_bitop3_b32 v14, v14, v53, v248 bitop3:0xf6
    v_bitop3_b32 v14, v14, v54, v248 bitop3:0xf6
    v_bitop3_b32 v14, v14, v55, v248 bitop3:0xf6
    v_and_b32 v15, 3, v14
    v_cmp_ne_u32 vcc, 0, v15
    s_cbranch_vccnz P_29
    v_and_b32 v40, -4, v40
    v_and_b32 v41, -4, v41
    v_and_b32 v42, -4, v42
    v_and_b32 v43, -4, v43
    v_and_b32 v44, -4, v44
    v_and_b32 v45, -4, v45
    v_and_b32 v46, -4, v46
    v_and_b32 v47, -4, v47
    v_and_b32 v48, -4, v48
    v_and_b32 v49, -4, v49
    v_and_b32 v50, -4, v50
    v_and_b32 v51, -4, v51
    v_and_b32 v52, -4, v52
    v_and_b32 v53, -4, v53
    v_and_b32 v54, -4, v54
    v_and_b32 v55, -4, v55
    v_pk_add_f32 v[40:41], v[40:41], v[44:45]
    v_pk_add_f32 v[42:43], v[42:43], v[46:47]
    v_pk_add_f32 v[48:49], v[48:49], v[52:53]
    v_pk_add_f32 v[50:51], v[50:51], v[54:55]
    v_cvt_pk_bf16_f32 v44, v40, v41
    v_lshlrev_b32 v40, 16, v44
    v_and_b32 v41, s62, v44
    v_cvt_pk_bf16_f32 v45, v42, v43
    v_lshlrev_b32 v42, 16, v45
    v_and_b32 v43, s62, v45
    v_cvt_pk_bf16_f32 v46, v48, v49
    v_lshlrev_b32 v48, 16, v46
    v_and_b32 v49, s62, v46
    v_cvt_pk_bf16_f32 v47, v50, v51
    v_lshlrev_b32 v50, 16, v47
    v_and_b32 v51, s62, v47
    v_add_f32 v48, 1.0, v48
    v_add_f32 v49, 1.0, v49
    v_add_f32 v50, 1.0, v50
    v_add_f32 v51, 1.0, v51
    v_cvt_pk_bf16_f32 v46, v48, v49
    v_lshlrev_b32 v48, 16, v46
    v_and_b32 v49, s62, v46
    v_cvt_pk_bf16_f32 v47, v50, v51
    v_lshlrev_b32 v50, 16, v47
    v_and_b32 v51, s62, v47
    v_pk_mul_f32 v[32:33], v[32:33], v[48:49]
    v_pk_mul_f32 v[34:35], v[34:35], v[50:51]
    v_cvt_pk_bf16_f32 v36, v32, v33
    v_lshlrev_b32 v32, 16, v36
    v_and_b32 v33, s62, v36
    v_cvt_pk_bf16_f32 v37, v34, v35
    v_lshlrev_b32 v34, 16, v37
    v_and_b32 v35, s62, v37
    v_pk_add_f32 v[32:33], v[32:33], v[40:41]
    v_pk_add_f32 v[34:35], v[34:35], v[42:43]
    v_cvt_pk_bf16_f32 v16, v32, v33
    v_cvt_pk_bf16_f32 v17, v34, v35
    s_nop 0
    v_mov_b32_dpp v96, v16 quad_perm:[0,0,0,0] row_mask:0xf bank_mask:0xf
    v_mov_b32_dpp v97, v17 quad_perm:[0,0,0,0] row_mask:0xf bank_mask:0xf
    v_mov_b32_dpp v98, v16 quad_perm:[1,1,1,1] row_mask:0xf bank_mask:0xf
    v_mov_b32_dpp v99, v17 quad_perm:[1,1,1,1] row_mask:0xf bank_mask:0xf
    v_mov_b32_dpp v100, v16 quad_perm:[2,2,2,2] row_mask:0xf bank_mask:0xf
    v_mov_b32_dpp v101, v17 quad_perm:[2,2,2,2] row_mask:0xf bank_mask:0xf
    v_mov_b32_dpp v102, v16 quad_perm:[3,3,3,3] row_mask:0xf bank_mask:0xf
    v_mov_b32_dpp v103, v17 quad_perm:[3,3,3,3] row_mask:0xf bank_mask:0xf
    s_waitcnt lgkmcnt(0)
    v_mfma_f32_16x16x32_bf16 v[104:107], v[128:131], v[96:99], 0
    v_mfma_f32_16x16x32_bf16 v[108:111], v[132:135], v[96:99], 0
    v_mfma_f32_16x16x32_bf16 v[112:115], v[136:139], v[96:99], 0
    v_mfma_f32_16x16x32_bf16 v[116:119], v[140:143], v[96:99], 0
    v_mfma_f32_16x16x32_bf16 v[104:107], v[144:147], v[100:103], v[104:107]
    v_mfma_f32_16x16x32_bf16 v[108:111], v[148:151], v[100:103], v[108:111]
    v_mfma_f32_16x16x32_bf16 v[112:115], v[152:155], v[100:103], v[112:115]
    v_mfma_f32_16x16x32_bf16 v[116:119], v[156:159], v[100:103], v[116:119]
    s_nop 5
    v_cndmask_b32 v104, v104, v108, s[50:51]
    v_cndmask_b32 v105, v105, v109, s[50:51]
    v_cndmask_b32 v106, v106, v110, s[50:51]
    v_cndmask_b32 v107, v107, v111, s[50:51]
    v_cndmask_b32 v104, v104, v112, s[52:53]
    v_cndmask_b32 v105, v105, v113, s[52:53]
    v_cndmask_b32 v106, v106, v114, s[52:53]
    v_cndmask_b32 v107, v107, v115, s[52:53]
    v_cndmask_b32 v104, v104, v116, s[54:55]
    v_cndmask_b32 v105, v105, v117, s[54:55]
    v_cndmask_b32 v106, v106, v118, s[54:55]
    v_cndmask_b32 v107, v107, v119, s[54:55]
    s_cmp_ge_u32 s3, 4
    ds_write_b128 v30, v[104:107]
    s_waitcnt lgkmcnt(0)
    s_barrier
    s_cbranch_scc1 L_W_q3
    ds_read2st64_b32 v[64:65], v31 offset0:0 offset1:5
    ds_read2st64_b32 v[66:67], v31 offset0:10 offset1:15
    ds_read2st64_b32 v[68:69], v31 offset0:20 offset1:25
    ds_read2st64_b32 v[70:71], v31 offset0:30 offset1:35
    s_waitcnt lgkmcnt(2)
    v_pk_add_f32 v[64:65], v[64:65], v[66:67]
    s_waitcnt lgkmcnt(0)
    v_pk_add_f32 v[68:69], v[68:69], v[70:71]
    v_pk_add_f32 v[64:65], v[64:65], v[68:69]
    v_add_f32 v64, v64, v65
    v_cvt_pk_bf16_f32 v64, v64, v64
    v_and_or_b32 v64, v64, s62, v250
    global_store_dword v56, v64, s[44:45]
    global_store_dword v57, v64, s[44:45] sc1
L_W_q3:
    v_lshlrev_b32 v8, 13, v7
    v_lshl_add_u32 v8, v9, 12, v8
    v_add_u32 v8, v8, v6
    s_lshl_b32 s6, s4, 19
    s_lshl_b32 s7, s3, 16
    s_add_u32 s6, s6, s7
    s_lshl_b32 s7, s5, 7
    s_add_u32 s6, s6, s7
    s_add_u32 s10, s24, s6
    s_addc_u32 s11, s25, 0
    s_sub_u32 s10, s10, 1024
    s_subb_u32 s11, s11, 0
    s_add_u32 m0, s14, 8192
    s_barrier
    s_cmp_ge_u32 s3, 4
    s_cbranch_scc1 L_W_pf
    s_mul_i32 s6, s5, 4
    s_add_u32 s6, s6, s3
    s_lshl_b32 s6, s6, 13
    s_lshl_b32 s7, s4, 19
    s_add_u32 s6, s6, s7
    s_add_u32 s6, s6, 262528
    v_lshrrev_b32 v20, 3, v1
    v_lshlrev_b32 v20, 10, v20
    v_and_b32 v21, 7, v1
    v_lshl_add_u32 v20, v21, 4, v20
    v_add_u32 v20, s6, v20
    global_load_dwordx4 v[240:243], v20, s[24:25]
L_W_pf:
    v_add_u32 v15, 1024, v8
    global_load_lds_dwordx4 v15, s[10:11] offset:0 nt
    v_add_u32 v15, 32768, v8
    global_load_lds_dwordx4 v15, s[10:11] offset:1024 nt
    global_load_lds_dwordx4 v8, s[10:11] offset:2048 nt
    v_add_u32 v15, 31744, v8
    global_load_lds_dwordx4 v15, s[10:11] offset:3072 nt
    s_add_u32 m0, m0, 0x1000
    v_add_u32 v15, 3072, v8
    global_load_lds_dwordx4 v15, s[10:11] offset:0 nt
    v_add_u32 v15, 34816, v8
    global_load_lds_dwordx4 v15, s[10:11] offset:1024 nt
    v_add_u32 v15, 2048, v8
    global_load_lds_dwordx4 v15, s[10:11] offset:2048 nt
    v_add_u32 v15, 33792, v8
    global_load_lds_dwordx4 v15, s[10:11] offset:3072 nt
    v_lshlrev_b32 v24, 13, v11
    v_lshl_add_u32 v24, v10, 2, v24
    s_lshl_b32 s6, s4, 15
    s_lshl_b32 s7, s3, 8
    s_add_u32 s6, s6, s7
    s_add_u32 s6, s6, 266240
    v_add_u32 v24, s6, v24
    s_lshl_b32 s6, s4, 11
    s_lshr_b32 s7, s3, 1
    s_lshl_b32 s7, s7, 4
    s_add_u32 s6, s6, s7
    s_add_u32 s6, s6, 196608
    v_lshl_add_u32 v25, v2, 7, s6
    v_mov_b32 v58, 0xff
    s_mov_b64 vcc, s[54:55]
    v_cndmask_b32 v58, 0, v58, vcc
    s_lshl_b32 s6, s3, 14
    v_lshl_add_u32 v19, v1, 2, s6
    s_lshl_b32 s6, s5, 11
    s_lshl_b32 s7, s4, 8
    s_add_u32 s6, s6, s7
    s_add_u32 s6, s6, 1048576
    v_add_u32 v19, s6, v19
    s_waitcnt vmcnt(0)
    ds_read_b64_tr_b16 v[160:161], v26 offset:8192
    ds_read_b64_tr_b16 v[162:163], v26 offset:10240
    ds_read_b64_tr_b16 v[164:165], v27 offset:8192
    ds_read_b64_tr_b16 v[166:167], v27 offset:10240
    ds_read_b64_tr_b16 v[168:169], v28 offset:8192
    ds_read_b64_tr_b16 v[170:171], v28 offset:10240
    ds_read_b64_tr_b16 v[172:173], v29 offset:8192
    ds_read_b64_tr_b16 v[174:175], v29 offset:10240
    ds_read_b64_tr_b16 v[176:177], v26 offset:12288
    ds_read_b64_tr_b16 v[178:179], v26 offset:14336
    ds_read_b64_tr_b16 v[180:181], v27 offset:12288
    ds_read_b64_tr_b16 v[182:183], v27 offset:14336
    ds_read_b64_tr_b16 v[184:185], v28 offset:12288
    ds_read_b64_tr_b16 v[186:187], v28 offset:14336
    ds_read_b64_tr_b16 v[188:189], v29 offset:12288
    ds_read_b64_tr_b16 v[190:191], v29 offset:14336
    s_mov_b64 exec, 0xffff
    s_mov_b32 s66, 0
P_33:
    s_add_u32 s66, s66, 1
    s_cmp_gt_u32 s66, 48
    s_cbranch_scc1 Ps_36
Pq_34:
    s_sleep 1
    global_load_dwordx4 v[40:43], v25, s[44:45] sc1
    s_waitcnt vmcnt(0)
    v_xor_b32 v14, v40, v248
    v_bitop3_b32 v14, v14, v41, v248 bitop3:0xf6
    v_bitop3_b32 v14, v14, v42, v248 bitop3:0xf6
    v_bitop3_b32 v14, v14, v43, v248 bitop3:0xf6
    v_and_b32 v15, 0xff, v14
    v_cmp_ne_u32 vcc, 0, v15
    s_cbranch_vccnz P_33
    s_mov_b64 exec, -1
    s_cmp_gt_u32 s66, 48
    s_cselect_b32 s6, 524288, 0
    v_or_b32 v24, s6, v24
    global_load_dwordx4 v[224:227], v24, s[44:45] offset:-4096 sc1
    global_load_dwordx4 v[228:231], v24, s[44:45] offset:-2048 sc1
    global_load_dwordx4 v[232:235], v24, s[44:45] offset:0 sc1
    global_load_dwordx4 v[236:239], v24, s[44:45] offset:2048 sc1
    v_and_b32 v40, s62, v40
    v_and_b32 v41, s63, v41
    s_nop 0
    v_max_f32_dpp v42, v40, v40 quad_perm:[1,0,3,2] row_mask:0xf bank_mask:0xf
    s_nop 1
    v_max_f32_dpp v42, v42, v42 quad_perm:[2,3,0,1] row_mask:0xf bank_mask:0xf
    v_sub_f32 v40, v40, v42
    v_mul_f32 v40, s64, v40
    v_exp_f32 v40, v40
    s_nop 0
    v_mul_f32 v41, v41, v40
    s_nop 1
    v_add_f32_dpp v41, v41, v41 quad_perm:[1,0,3,2] row_mask:0xf bank_mask:0xf
    s_nop 1
    v_add_f32_dpp v41, v41, v41 quad_perm:[2,3,0,1] row_mask:0xf bank_mask:0xf
    v_rcp_f32 v41, v41
    s_nop 0
    v_mul_f32 v40, v40, v41
    v_mov_b32 v41, v40
    s_nop 1
    v_permlane16_swap_b32 v40, v41
    v_mov_b32 v41, v40
    s_nop 1
    v_permlane32_swap_b32 v40, v41
    s_nop 1
    v_mov_b32_dpp v32, v40 quad_perm:[0,0,0,0] row_mask:0xf bank_mask:0xf
    v_mov_b32_dpp v34, v40 quad_perm:[1,1,1,1] row_mask:0xf bank_mask:0xf
    v_mov_b32_dpp v36, v40 quad_perm:[2,2,2,2] row_mask:0xf bank_mask:0xf
    v_mov_b32_dpp v38, v40 quad_perm:[3,3,3,3] row_mask:0xf bank_mask:0xf
    s_waitcnt lgkmcnt(0)
    s_mov_b32 s66, 0
    s_waitcnt vmcnt(0)
    s_branch Gc_38
G_37:
    s_wqm_b64 exec, s[6:7]
    global_load_dwordx4 v[224:227], v24, s[44:45] offset:-4096 sc1
    s_wqm_b64 exec, s[8:9]
    global_load_dwordx4 v[228:231], v24, s[44:45] offset:-2048 sc1
    s_wqm_b64 exec, s[10:11]
    global_load_dwordx4 v[232:235], v24, s[44:45] offset:0 sc1
    s_wqm_b64 exec, s[12:13]
    global_load_dwordx4 v[236:239], v24, s[44:45] offset:2048 sc1
    s_mov_b64 exec, -1
    s_add_u32 s66, s66, 1
    s_cmp_gt_u32 s66, 40
    s_cbranch_scc1 Gs_39
Gb_40:
    s_waitcnt vmcnt(0)
Gc_38:
    v_cmp_ne_u32_sdwa s[6:7], v227, v248 src0_sel:BYTE_0 src1_sel:BYTE_0
    v_cmp_ne_u32_sdwa s[8:9], v231, v248 src0_sel:BYTE_0 src1_sel:BYTE_0
    v_cmp_ne_u32_sdwa s[10:11], v235, v248 src0_sel:BYTE_0 src1_sel:BYTE_0
    v_cmp_ne_u32_sdwa s[12:13], v239, v248 src0_sel:BYTE_0 src1_sel:BYTE_0
    s_or_b64 vcc, s[6:7], s[8:9]
    s_or_b64 vcc, vcc, s[10:11]
    s_or_b64 vcc, vcc, s[12:13]
    s_cbranch_scc1 G_37
L_W_h3:
    v_and_b32 v227, s63, v227
    v_and_b32 v231, s63, v231
    v_and_b32 v235, s63, v235
    v_and_b32 v239, s63, v239
    v_pk_mul_f32 v[40:41], v[224:225], v[32:33] op_sel_hi:[1,0]
    v_pk_mul_f32 v[42:43], v[226:227], v[32:33] op_sel_hi:[1,0]
    v_pk_fma_f32 v[40:41], v[228:229], v[34:35], v[40:41] op_sel_hi:[1,0,1]
    v_pk_fma_f32 v[42:43], v[230:231], v[34:35], v[42:43] op_sel_hi:[1,0,1]
    v_pk_fma_f32 v[40:41], v[232:233], v[36:37], v[40:41] op_sel_hi:[1,0,1]
    v_pk_fma_f32 v[42:43], v[234:235], v[36:37], v[42:43] op_sel_hi:[1,0,1]
    v_pk_fma_f32 v[40:41], v[236:237], v[38:39], v[40:41] op_sel_hi:[1,0,1]
    v_pk_fma_f32 v[42:43], v[238:239], v[38:39], v[42:43] op_sel_hi:[1,0,1]
    v_cvt_pk_bf16_f32 v16, v40, v41
    v_cvt_pk_bf16_f32 v17, v42, v43
    s_nop 0
    v_mov_b32_dpp v96, v16 quad_perm:[0,0,0,0] row_mask:0xf bank_mask:0xf
    v_mov_b32_dpp v97, v17 quad_perm:[0,0,0,0] row_mask:0xf bank_mask:0xf
    v_mov_b32_dpp v98, v16 quad_perm:[1,1,1,1] row_mask:0xf bank_mask:0xf
    v_mov_b32_dpp v99, v17 quad_perm:[1,1,1,1] row_mask:0xf bank_mask:0xf
    v_mov_b32_dpp v100, v16 quad_perm:[2,2,2,2] row_mask:0xf bank_mask:0xf
    v_mov_b32_dpp v101, v17 quad_perm:[2,2,2,2] row_mask:0xf bank_mask:0xf
    v_mov_b32_dpp v102, v16 quad_perm:[3,3,3,3] row_mask:0xf bank_mask:0xf
    v_mov_b32_dpp v103, v17 quad_perm:[3,3,3,3] row_mask:0xf bank_mask:0xf
    v_mfma_f32_16x16x32_bf16 v[104:107], v[160:163], v[96:99], 0
    v_mfma_f32_16x16x32_bf16 v[108:111], v[164:167], v[96:99], 0
    v_mfma_f32_16x16x32_bf16 v[112:115], v[168:171], v[96:99], 0
    v_mfma_f32_16x16x32_bf16 v[116:119], v[172:175], v[96:99], 0
    v_mfma_f32_16x16x32_bf16 v[104:107], v[176:179], v[100:103], v[104:107]
    v_mfma_f32_16x16x32_bf16 v[108:111], v[180:183], v[100:103], v[108:111]
    v_mfma_f32_16x16x32_bf16 v[112:115], v[184:187], v[100:103], v[112:115]
    v_mfma_f32_16x16x32_bf16 v[116:119], v[188:191], v[100:103], v[116:119]
    s_nop 5
    v_cndmask_b32 v104, v104, v108, s[50:51]
    v_cndmask_b32 v105, v105, v109, s[50:51]
    v_cndmask_b32 v106, v106, v110, s[50:51]
    v_cndmask_b32 v107, v107, v111, s[50:51]
    v_cndmask_b32 v104, v104, v112, s[52:53]
    v_cndmask_b32 v105, v105, v113, s[52:53]
    v_cndmask_b32 v106, v106, v114, s[52:53]
    v_cndmask_b32 v107, v107, v115, s[52:53]
    v_cndmask_b32 v104, v104, v116, s[54:55]
    v_cndmask_b32 v105, v105, v117, s[54:55]
    v_cndmask_b32 v106, v106, v118, s[54:55]
    v_cndmask_b32 v107, v107, v119, s[54:55]
    s_cmp_ge_u32 s3, 4
    ds_write_b128 v30, v[104:107]
    s_waitcnt lgkmcnt(0)
    s_barrier
    s_cbranch_scc1 L_end
    ds_read2st64_b32 v[64:65], v31 offset0:0 offset1:5
    ds_read2st64_b32 v[66:67], v31 offset0:10 offset1:15
    ds_read2st64_b32 v[68:69], v31 offset0:20 offset1:25
    ds_read2st64_b32 v[70:71], v31 offset0:30 offset1:35
    s_waitcnt lgkmcnt(2)
    v_pk_add_f32 v[64:65], v[64:65], v[66:67]
    s_waitcnt lgkmcnt(0)
    v_pk_add_f32 v[68:69], v[68:69], v[70:71]
    v_pk_add_f32 v[64:65], v[64:65], v[68:69]
    v_add_f32 v64, v64, v65
    v_bfi_b32 v64, v58, v248, v64
    global_store_dword v19, v64, s[44:45] sc1
    s_endpgm
L_A_g1:
    global_load_dwordx4 v[96:99], v9, s[12:13] offset:0 nt
    global_load_dwordx4 v[100:103], v9, s[12:13] offset:1024 nt
    global_load_dwordx4 v[104:107], v9, s[12:13] offset:2048 nt
    global_load_dwordx4 v[108:111], v9, s[12:13] offset:3072 nt
    s_xor_b32 s9, s8, 12288
    s_add_u32 s12, s20, s9
    s_addc_u32 s13, s21, 0
    global_load_dwordx4 v[112:115], v9, s[12:13] offset:0 nt
    global_load_dwordx4 v[116:119], v9, s[12:13] offset:1024 nt
    global_load_dwordx4 v[120:123], v9, s[12:13] offset:2048 nt
    global_load_dwordx4 v[124:127], v9, s[12:13] offset:3072 nt
    s_waitcnt vmcnt(18)
    ds_read_b128 v[128:131], v5 offset:0
    ds_read_b128 v[132:135], v6 offset:0
    ds_read_b128 v[136:139], v7 offset:0
    ds_read_b128 v[140:143], v8 offset:0
    ds_read_b128 v[144:147], v5 offset:4096
    ds_read_b128 v[148:151], v6 offset:4096
    ds_read_b128 v[152:155], v7 offset:4096
    ds_read_b128 v[156:159], v8 offset:4096
    ds_read_b128 v[160:163], v5 offset:8192
    ds_read_b128 v[164:167], v6 offset:8192
    ds_read_b128 v[168:171], v7 offset:8192
    ds_read_b128 v[172:175], v8 offset:8192
    ds_read_b128 v[176:179], v5 offset:12288
    ds_read_b128 v[180:183], v6 offset:12288
    ds_read_b128 v[184:187], v7 offset:12288
    ds_read_b128 v[188:191], v8 offset:12288
    s_waitcnt vmcnt(8)
    s_branch L_A_g1r
P_2:
    s_add_u32 s66, s66, 1
    s_cmp_gt_u32 s66, 8
    s_cbranch_scc1 Ps_5
Pq_3:
    global_load_dwordx4 v[192:195], v12, s[44:45] offset:0 sc1
    global_load_dwordx4 v[196:199], v12, s[44:45] offset:1024 sc1
    s_waitcnt vmcnt(0)
    s_branch Pc_4
Ps_5:
    s_cmp_gt_u32 s66, 1048576
    s_cbranch_scc1 L_end
    v_mov_b32 v14, 524288
    v_cndmask_b32 v14, 0, v14, vcc
    v_xor_b32 v12, v12, v14
    s_branch Pq_3
L_A_ml:
    v_lshlrev_b32 v14, 5, v251
    v_add_u32 v14, 131136, v14
    ds_read_b128 v[16:19], v14
    ds_read_b128 v[20:23], v14 offset:16
    s_lshl_b32 s9, s15, 7
    s_add_u32 s9, s9, 196608
    v_lshl_add_u32 v13, v2, 2, s9
    v_and_b32 v14, 1, v0
    v_cmp_ne_u32 vcc, 0, v14
    v_add_u32 v14, 524288, v13
    s_waitcnt lgkmcnt(0)
    v_pk_add_f32 v[16:17], v[16:17], v[18:19]
    v_pk_add_f32 v[20:21], v[20:21], v[22:23]
    v_pk_add_f32 v[16:17], v[16:17], v[20:21]
    v_add_f32 v16, v16, v17
    v_cndmask_b32 v16, v27, v16, vcc
    v_and_or_b32 v16, v16, s63, v248
    s_mov_b64 exec, 0xffff
    global_store_dword v13, v16, s[44:45]
    global_store_dword v14, v16, s[44:45] sc1
    s_mov_b64 exec, -1
    s_waitcnt vmcnt(8)
    v_perm_b32 v160, v100, v96, s61
    v_perm_b32 v164, v100, v96, s60
    v_perm_b32 v168, v101, v97, s61
    v_perm_b32 v172, v101, v97, s60
    v_perm_b32 v176, v102, v98, s61
    v_perm_b32 v180, v102, v98, s60
    v_perm_b32 v184, v103, v99, s61
    v_perm_b32 v188, v103, v99, s60
    s_waitcnt vmcnt(6)
    v_perm_b32 v161, v108, v104, s61
    v_perm_b32 v165, v108, v104, s60
    v_perm_b32 v169, v109, v105, s61
    v_perm_b32 v173, v109, v105, s60
    v_perm_b32 v177, v110, v106, s61
    v_perm_b32 v181, v110, v106, s60
    v_perm_b32 v185, v111, v107, s61
    v_perm_b32 v189, v111, v107, s60
    s_waitcnt vmcnt(4)
    v_perm_b32 v162, v116, v112, s61
    v_perm_b32 v166, v116, v112, s60
    v_perm_b32 v170, v117, v113, s61
    v_perm_b32 v174, v117, v113, s60
    v_perm_b32 v178, v118, v114, s61
    v_perm_b32 v182, v118, v114, s60
    v_perm_b32 v186, v119, v115, s61
    v_perm_b32 v190, v119, v115, s60
    s_waitcnt vmcnt(2)
    s_branch L_A_pv1
L_A_pub2:
    v_add_u32 v254, 524288, v254
    global_store_dwordx2 v254, v[16:17], s[44:45] sc1
    s_branch L_A_pub3
L_F_m2:
    ds_read_b64_tr_b16 v[144:145], v26 offset:4096
    ds_read_b64_tr_b16 v[146:147], v26 offset:6144
    ds_read_b64_tr_b16 v[148:149], v27 offset:4096
    ds_read_b64_tr_b16 v[150:151], v27 offset:6144
    ds_read_b64_tr_b16 v[152:153], v28 offset:4096
    ds_read_b64_tr_b16 v[154:155], v28 offset:6144
    ds_read_b64_tr_b16 v[156:157], v29 offset:4096
    ds_read_b64_tr_b16 v[158:159], v29 offset:6144
    s_waitcnt lgkmcnt(0)
    v_mfma_f32_16x16x32_bf16 v[104:107], v[144:147], v[100:103], v[104:107]
    v_mfma_f32_16x16x32_bf16 v[108:111], v[148:151], v[100:103], v[108:111]
    v_mfma_f32_16x16x32_bf16 v[112:115], v[152:155], v[100:103], v[112:115]
    v_mfma_f32_16x16x32_bf16 v[116:119], v[156:159], v[100:103], v[116:119]
    s_branch L_F_m1
L_F_late:
    v_cvt_pk_bf16_f32 v64, v64, v64
    v_and_or_b32 v64, v64, s62, v249
    global_store_dword v51, v64, s[44:45] sc1
    s_branch L_F_m3
P_19:
    s_add_u32 s66, s66, 1
    s_cmp_gt_u32 s66, 1048576
    s_cbranch_scc1 Ps_22
Pq_20:
    global_load_dwordx4 v[196:199], v41, s[44:45] offset:-2048 sc1
    global_load_dwordx4 v[48:51], v41, s[44:45] sc1
    global_load_dwordx4 v[200:203], v41, s[44:45] offset:2048 sc1
    s_waitcnt vmcnt(0)
    s_branch Pc_21
Ps_22:
    s_endpgm
Ps_36:
    s_cmp_gt_u32 s66, 1048576
    s_cbranch_scc1 L_end
    v_mov_b32 v15, 524288
    v_cndmask_b32 v15, 0, v15, vcc
    v_xor_b32 v25, v25, v15
    s_branch Pq_34
Gs_39:
    s_cmp_gt_u32 s66, 1048576
    s_cbranch_scc1 L_end
    v_or_b32 v24, 524288, v24
    s_branch Gb_40
L_end:
L_exit:
    s_endpgm
    .fill (16640 - (. - adaLN_cond__sliding_block_cached__dense_activation_squared_relu__decode_kernel)) / 4, 4, 0xbf810000
.section .rodata,"a"
.p2align 6
.amdhsa_kernel adaLN_cond__sliding_block_cached__dense_activation_squared_relu__decode_kernel
  .amdhsa_next_free_vgpr 256
  .amdhsa_next_free_sgpr 102
  .amdhsa_accum_offset 256
  .amdhsa_group_segment_fixed_size 0
  .amdhsa_kernarg_size 120
  .amdhsa_user_sgpr_count 2
  .amdhsa_user_sgpr_kernarg_segment_ptr 1
  .amdhsa_system_sgpr_workgroup_id_x 1
  .amdhsa_float_denorm_mode_32 3
  .amdhsa_float_denorm_mode_16_64 3
.end_amdhsa_kernel
```
